```python
import torch

def _softmax(x, axis=-1):
    return torch.softmax(x, dim=axis)
def _gelu(x):
    return torch.nn.functional.gelu(x, approximate="tanh")
def _silu(x):
    return torch.nn.functional.silu(x)
def _sigmoid(x):
    return torch.sigmoid(x)
def _layernorm(x, axis=-1, eps=1e-5):
    m = x.mean(dim=axis, keepdim=True)
    v = x.var(dim=axis, keepdim=True, unbiased=False)
    return (x - m) / torch.sqrt(v + eps)
def _scatter_add(tgt, idx, src, axis=0):
    return tgt.clone().index_add_(axis, idx, src)
def _segment_sum(src, seg, n):
    out = torch.zeros((n,) + src.shape[1:], dtype=src.dtype)
    return out.index_add_(0, seg, src)
def _pad(x, pw):
    flat = tuple(v for pair in reversed(pw) for v in pair)
    return torch.nn.functional.pad(x, flat)

kernel_name = 'recurrent_scan__sliding_local_dilated__dense_activation_squared_relu__prompt'

def setup_inputs():

    _w = (lambda a: (lambda t: t.to(torch.bfloat16) if t.is_floating_point() else t)(torch.as_tensor(a)))
    def _A_setup():
        B, S, D = 1, 2048, 640
        return {
            "x": _w((lambda *s: torch.randn(*s, dtype=torch.bfloat16) * 0.05)(B, S, D)),
            "wqkv": _w((lambda *s: torch.randn(*s, dtype=torch.bfloat16) * 0.05)(D, 3 * D)),
            "wo": _w((lambda *s: torch.randn(*s, dtype=torch.bfloat16) * 0.05)(D, D)),
        }
    _A_in = _A_setup()

    def _B_setup():
        B, S, D, F = 1, 2048, 640, 1536
        return {
            "x": _w((lambda *s: torch.randn(*s, dtype=torch.bfloat16) * 0.05)(B, S, D)),
            "w1": _w((lambda *s: torch.randn(*s, dtype=torch.bfloat16) * 0.05)(D, F)),
            "b1": _w((lambda *s: torch.randn(*s, dtype=torch.bfloat16) * 0.4)(F)),
            "w2": _w((lambda *s: torch.randn(*s, dtype=torch.bfloat16) * 0.05)(F, D)),
            "b2": _w((lambda *s: torch.randn(*s, dtype=torch.bfloat16) * 1.6)(D)),
        }
    _B_in = _B_setup()

    return {
        "A_x": _A_in["x"],
        "A_wqkv": _A_in["wqkv"],
        "A_wo": _A_in["wo"],
        "B_x": _B_in["x"],
        "B_w1": _B_in["w1"],
        "B_b1": _B_in["b1"],
        "B_w2": _B_in["w2"],
        "B_b2": _B_in["b2"],
    }

def reference(A_x, A_wqkv, A_wo, B_x, B_w1, B_b1, B_w2, B_b2):
    def _A_ref(x, wqkv, wo):
        B, S, D = x.shape
        H = 32; Dh = D // H
        W, dil = 8, 2
        qkv = (lambda x, *d: x.permute(*d))((x @ wqkv).reshape(B, S, 3, H, Dh), 2, 0, 3, 1, 4)
        q, k, v = qkv[0], qkv[1], qkv[2]
        scale = Dh ** -0.5
        pos = torch.arange(S)
        off = torch.arange(W) * dil
        idx = pos[:, None] - off[None, :]
        mask = idx >= 0
        idx_c = torch.where(mask, idx, 0).reshape(-1)
        kg = k[:, :, idx_c, :].reshape(B, H, S, W, Dh)
        vg = v[:, :, idx_c, :].reshape(B, H, S, W, Dh)
        logits = torch.einsum("bhsd,bhswd->bhsw", q, kg) * scale
        logits = torch.where(mask[None, None, :, :], logits, -1e9)
        attn = _softmax(logits, axis=-1)
        o = torch.einsum("bhsw,bhswd->bhsd", attn, vg)
        return (lambda x, *d: x.permute(*d))(o, 0, 2, 1, 3).reshape(B, S, D) @ wo

    def _B_ref(x, w1, b1, w2, b2):
        h = torch.einsum("bsd,df->bsf", x, w1) + b1
        zero = torch.zeros_like(h)
        r = torch.where(h > zero, h, zero)
        h = r * r
        out = torch.einsum("bsf,fd->bsd", h, w2) + b2
        return out

    x = A_x
    xn = _layernorm(x, axis=-1)
    s = _A_ref(xn, A_wqkv, A_wo)
    g = _silu(_B_ref(xn, B_w1, B_b1, B_w2, B_b2))
    return x + s * g
```

```asm
; @launch grid=(256,1,1) block=(768,1,1) lds=161280
.amdgcn_target "amdgcn-amd-amdhsa--gfx950"
.text
.globl recurrent_scan__sliding_local_dilated__dense_activation_squared_relu__prompt_kernel
.p2align 8
.type recurrent_scan__sliding_local_dilated__dense_activation_squared_relu__prompt_kernel,@function
recurrent_scan__sliding_local_dilated__dense_activation_squared_relu__prompt_kernel:
    s_cmp_ge_u32 s2, 256
    s_cbranch_scc1 L_end
    s_load_dwordx4 s[4:7], s[0:1], 0
    s_load_dwordx8 s[32:39], s[0:1], 32
    s_load_dwordx2 s[28:29], s[0:1], 16
    s_load_dwordx4 s[64:67], s[0:1], 64
    s_load_dwordx2 s[68:69], s[0:1], 80
    v_lshrrev_b32 v16, 6, v0
    v_and_b32 v1, 63, v0
    v_readfirstlane_b32 s40, v16
    s_and_b32 s56, s2, 3
    s_lshl_b32 s56, s56, 1
    s_bfe_u32 s42, s2, 0x10004
    s_add_u32 s42, s42, s56
    s_bfe_u32 s56, s2, 0x10002
    s_lshl_b32 s56, s56, 3
    s_lshr_b32 s43, s2, 5
    s_add_u32 s43, s43, s56
    s_and_b32 s41, s40, 3
    v_lshrrev_b32 v16, 4, v1
    s_cmp_lt_u32 s40, 8
    s_cbranch_scc1 L_compute
    v_and_b32 v17, 7, v1
    v_xor_b32 v21, v17, v16
    v_lshlrev_b32 v21, 4, v21
    v_lshrrev_b32 v18, 3, v1
    v_mul_u32_u24 v18, 2560, v18
    v_add_u32 v19, v18, v21
    v_xor_b32 v21, 64, v21
    v_add_u32 v20, v18, v21
    s_lshl_b32 s56, s43, 7
    s_lshl_b32 s57, s41, 5
    s_add_u32 s57, s57, s56
    s_mul_i32 s57, s57, 1280
    v_add_u32 v2, s57, v19
    s_add_u32 s57, s57, 19456
    v_add_u32 v3, s57, v20
    s_mov_b32 s46, 0
    s_mov_b32 s47, 0
    s_bitcmp1_b32 s2, 3
    s_cbranch_scc1 L_ldF
    s_lshl_b32 s57, s41, 1
    v_add_u32 v19, s57, v16
    v_xor_b32 v19, v19, v17
    v_and_b32 v19, 7, v19
    v_lshl_add_u32 v19, v19, 4, v18
    s_and_b32 s57, s41, 1
    s_lshl_b32 s57, s57, 3
    s_lshr_b32 s58, s41, 1
    s_add_u32 s57, s57, s58
    s_add_u32 s57, s57, s56
    s_sub_u32 s57, s57, 16
    s_mul_i32 s57, s57, 1280
    v_add_u32 v4, s57, v19
    s_lshl_b32 s51, s41, 9
    s_add_u32 s51, s51, 31744
    s_cmp_eq_u32 s41, 0
    s_cselect_b32 s54, 0xffffff00, -1
    s_mov_b32 s55, 0
    v_cmp_le_u32 vcc, 30, v1
    v_mov_b32 v19, 0
    v_mov_b32 v20, 30
    v_cndmask_b32 v19, v19, v20, vcc
    v_sub_u32 v20, v1, v19
    v_mul_u32_u24 v19, 128, v19
    v_mul_u32_u24 v21, 26, v20
    v_lshrrev_b32 v21, 8, v21
    v_mul_u32_u24 v22, 10, v21
    v_sub_u32 v20, v20, v22
    v_lshl_add_u32 v19, v20, 4, v19
    v_add_u32 v21, 1, v21
    v_cmp_le_u32 vcc, 3, v21
    v_mov_b32 v22, 0
    s_mul_i32 s56, s41, 30720
    v_cndmask_b32 v21, v21, v22, vcc
    v_mul_u32_u24 v21, 1280, v21
    v_add_u32 v19, v19, v21
    s_mul_i32 s57, s42, 160
    s_add_u32 s56, s56, s57
    v_add_u32 v6, s56, v19
    v_add_u32 v7, 6720, v6
    v_add_u32 v8, 13440, v6
    v_add_u32 v9, 20160, v6
    s_mul_i32 s49, s41, 3968
    s_lshl_b32 s50, s41, 12
    s_add_u32 s50, s50, 33792
    s_mov_b32 s52, -1
    s_mov_b32 s53, 0x0fffffff
    s_waitcnt lgkmcnt(0)
    s_mov_b32 s8, s4
    s_and_b32 s9, s5, 0xffff
    s_mov_b32 s10, 2621440
    s_mov_b32 s11, 0x00020000
    s_mov_b32 s12, s6
    s_and_b32 s13, s7, 0xffff
    s_mov_b32 s14, 2457600
    s_mov_b32 s15, 0x00020000
    s_mov_b32 s44, 0
    s_add_u32 s30, s68, 11796480
    s_addc_u32 s31, s69, 0
    s_load_dwordx2 s[30:31], s[30:31], 0
    s_add_u32 m0, s44, s50
    s_add_u32 s56, s47, 1280
    buffer_load_dwordx4 v2, s[8:11], s47 offen lds
    buffer_load_dwordx4 v3, s[8:11], s47 offen offset:1024 lds
    s_add_u32 m0, m0, 2048
    s_nop 0
    buffer_load_dwordx4 v2, s[8:11], s56 offen lds
    buffer_load_dwordx4 v3, s[8:11], s56 offen offset:1024 lds
    s_add_u32 m0, s44, s51
    s_mov_b64 exec, s[54:55]
    buffer_load_dwordx4 v4, s[8:11], s47 offen lds
    s_add_u32 m0, s44, s49
    s_mov_b64 exec, s[52:53]
    buffer_load_dwordx4 v6, s[12:15], s46 offen offset:0 lds
    buffer_load_dwordx4 v7, s[12:15], s46 offen offset:960 lds
    buffer_load_dwordx4 v8, s[12:15], s46 offen offset:1920 lds
    buffer_load_dwordx4 v9, s[12:15], s46 offen offset:2880 lds
    s_add_u32 m0, m0, 15872
    s_add_u32 s56, s46, 122880
    buffer_load_dwordx4 v6, s[12:15], s56 offen offset:0 lds
    buffer_load_dwordx4 v7, s[12:15], s56 offen offset:960 lds
    buffer_load_dwordx4 v8, s[12:15], s56 offen offset:1920 lds
    buffer_load_dwordx4 v9, s[12:15], s56 offen offset:2880 lds
    s_mov_b64 exec, -1
    s_add_u32 s46, s46, 245760
    s_add_u32 s47, s47, 128
    s_add_u32 s44, s44, 50176
    s_cmp_eq_u32 s44, 150528
    s_cselect_b32 s44, 0, s44
    s_add_u32 m0, s44, s50
    s_add_u32 s56, s47, 1280
    buffer_load_dwordx4 v2, s[8:11], s47 offen lds
    buffer_load_dwordx4 v3, s[8:11], s47 offen offset:1024 lds
    s_add_u32 m0, m0, 2048
    s_nop 0
    buffer_load_dwordx4 v2, s[8:11], s56 offen lds
    buffer_load_dwordx4 v3, s[8:11], s56 offen offset:1024 lds
    s_add_u32 m0, s44, s51
    s_mov_b64 exec, s[54:55]
    buffer_load_dwordx4 v4, s[8:11], s47 offen lds
    s_add_u32 m0, s44, s49
    s_mov_b64 exec, s[52:53]
    buffer_load_dwordx4 v6, s[12:15], s46 offen offset:0 lds
    buffer_load_dwordx4 v7, s[12:15], s46 offen offset:960 lds
    buffer_load_dwordx4 v8, s[12:15], s46 offen offset:1920 lds
    buffer_load_dwordx4 v9, s[12:15], s46 offen offset:2880 lds
    s_add_u32 m0, m0, 15872
    s_add_u32 s56, s46, 122880
    buffer_load_dwordx4 v6, s[12:15], s56 offen offset:0 lds
    buffer_load_dwordx4 v7, s[12:15], s56 offen offset:960 lds
    buffer_load_dwordx4 v8, s[12:15], s56 offen offset:1920 lds
    buffer_load_dwordx4 v9, s[12:15], s56 offen offset:2880 lds
    s_mov_b64 exec, -1
    s_add_u32 s46, s46, 245760
    s_add_u32 s47, s47, 128
    s_add_u32 s44, s44, 50176
    s_cmp_eq_u32 s44, 150528
    s_cselect_b32 s44, 0, s44
    s_mov_b32 s16, s68
    s_and_b32 s17, s69, 0xffff
    s_mov_b32 s18, 11796608
    s_mov_b32 s19, 0x00020000
    s_waitcnt vmcnt(13) lgkmcnt(0)
    s_barrier
    s_add_u32 m0, s44, s50
    s_add_u32 s56, s47, 1280
    buffer_load_dwordx4 v2, s[8:11], s47 offen lds
    buffer_load_dwordx4 v3, s[8:11], s47 offen offset:1024 lds
    s_add_u32 m0, m0, 2048
    s_nop 0
    buffer_load_dwordx4 v2, s[8:11], s56 offen lds
    buffer_load_dwordx4 v3, s[8:11], s56 offen offset:1024 lds
    s_add_u32 m0, s44, s51
    s_mov_b64 exec, s[54:55]
    buffer_load_dwordx4 v4, s[8:11], s47 offen lds
    s_add_u32 m0, s44, s49
    s_mov_b64 exec, s[52:53]
    buffer_load_dwordx4 v6, s[12:15], s46 offen offset:0 lds
    buffer_load_dwordx4 v7, s[12:15], s46 offen offset:960 lds
    buffer_load_dwordx4 v8, s[12:15], s46 offen offset:1920 lds
    buffer_load_dwordx4 v9, s[12:15], s46 offen offset:2880 lds
    s_add_u32 m0, m0, 15872
    s_add_u32 s56, s46, 122880
    buffer_load_dwordx4 v6, s[12:15], s56 offen offset:0 lds
    buffer_load_dwordx4 v7, s[12:15], s56 offen offset:960 lds
    buffer_load_dwordx4 v8, s[12:15], s56 offen offset:1920 lds
    buffer_load_dwordx4 v9, s[12:15], s56 offen offset:2880 lds
    s_mov_b64 exec, -1
    s_add_u32 s46, s46, 245760
    s_add_u32 s47, s47, 128
    s_add_u32 s44, s44, 50176
    s_cmp_eq_u32 s44, 150528
    s_cselect_b32 s44, 0, s44
    v_lshlrev_b32 v26, 4, v1
    v_lshlrev_b32 v25, 7, v1
    v_lshlrev_b32 v27, 2, v1
    s_add_u32 s30, s30, 1
    s_addc_u32 s31, s31, 0
    v_lshrrev_b32 v32, 2, v1
    v_lshlrev_b32 v32, 4, v32
    v_bfe_u32 v16, v1, 1, 1
    v_lshl_add_u32 v32, v16, 2, v32
    v_and_b32 v16, 1, v1
    v_add_u32 v32, v32, v16
    s_and_b32 s56, s2, 1
    s_lshl_b32 s56, s56, 1
    s_add_u32 s56, s56, 8
    v_add_lshl_u32 v32, v32, s56, 7
    s_mul_i32 s56, s41, 36
    s_sub_u32 s56, s56, 16
    v_add_u32 v16, s56, v1
    s_lshl_b32 s56, s43, 7
    v_add_u32 v17, s56, v16
    v_max_i32 v17, 0, v17
    v_lshlrev_b32 v33, 4, v17
    v_ashrrev_i32 v17, 5, v16
    v_and_b32 v18, 1, v16
    v_lshl_add_u32 v17, v17, 1, v18
    v_bfe_u32 v19, v16, 1, 4
    v_lshl_add_u32 v17, v17, 4, v19
    v_add_u32 v17, 16, v17
    v_and_b32 v19, 7, v19
    v_cmp_gt_i32 vcc, 0, v16
    v_lshl_add_u32 v19, v18, 3, v19
    s_nop 0
    v_cndmask_b32 v17, v17, v19, vcc
    v_lshlrev_b32 v34, 3, v17
    v_add_u32 v34, 150528, v34
    v_add_u32 v17, 16, v16
    v_lshrrev_b32 v17, 1, v17
    v_mul_u32_u24 v18, 320, v18
    v_lshl_add_u32 v35, v17, 2, v18
    v_add_u32 v35, 152640, v35
    s_bfe_u32 s56, s2, 0x10001
    s_lshl_b32 s57, s43, 1
    s_add_u32 s56, s56, s57
    s_lshl_b32 s76, s43, 11
    s_add_u32 s76, s76, 11730944
    s_lshl_b32 s70, s56, 2
    s_add_u32 s70, s70, s41
    s_mul_i32 s70, s70, 69632
    s_and_b32 s56, s2, 1
    s_lshl_b32 s56, s56, 2
    s_bfe_u32 s57, s2, 0x20003
    s_add_u32 s56, s56, s57
    s_mul_i32 s71, s56, 68
    s_add_u32 s71, s71, s41
    s_mul_i32 s71, s71, 5120
    s_add_u32 s71, s71, 8912896
    s_mul_i32 s74, s41, 5120
    s_lshl_b32 s73, s41, 12
    s_add_u32 s73, s73, 20480
    s_mov_b32 s75, 1
    s_mov_b32 s48, 0
L_ldQ_loop:
    s_waitcnt vmcnt(13)
    s_barrier
    s_add_u32 m0, s44, s50
    s_add_u32 s56, s47, 1280
    buffer_load_dwordx4 v2, s[8:11], s47 offen lds
    buffer_load_dwordx4 v3, s[8:11], s47 offen offset:1024 lds
    s_add_u32 m0, m0, 2048
    s_nop 0
    buffer_load_dwordx4 v2, s[8:11], s56 offen lds
    buffer_load_dwordx4 v3, s[8:11], s56 offen offset:1024 lds
    s_add_u32 m0, s44, s51
    s_mov_b64 exec, s[54:55]
    buffer_load_dwordx4 v4, s[8:11], s47 offen lds
    s_add_u32 m0, s44, s49
    s_mov_b64 exec, s[52:53]
    buffer_load_dwordx4 v6, s[12:15], s46 offen offset:0 lds
    buffer_load_dwordx4 v7, s[12:15], s46 offen offset:960 lds
    buffer_load_dwordx4 v8, s[12:15], s46 offen offset:1920 lds
    buffer_load_dwordx4 v9, s[12:15], s46 offen offset:2880 lds
    s_add_u32 m0, m0, 15872
    s_add_u32 s56, s46, 122880
    buffer_load_dwordx4 v6, s[12:15], s56 offen offset:0 lds
    buffer_load_dwordx4 v7, s[12:15], s56 offen offset:960 lds
    buffer_load_dwordx4 v8, s[12:15], s56 offen offset:1920 lds
    buffer_load_dwordx4 v9, s[12:15], s56 offen offset:2880 lds
    s_mov_b64 exec, -1
    s_add_u32 s46, s46, 245760
    s_add_u32 s47, s47, 128
    s_add_u32 s44, s44, 50176
    s_cmp_eq_u32 s44, 150528
    s_cselect_b32 s44, 0, s44
    s_add_u32 s48, s48, 1
    s_cmp_lt_u32 s48, 7
    s_cbranch_scc1 L_ldQ_loop
    s_waitcnt vmcnt(13)
    s_barrier
    s_mov_b32 s56, 11698176
    s_mov_b32 s58, -1
    s_mov_b32 s59, 15
    s_mov_b64 exec, s[58:59]
    buffer_load_dwordx4 v[36:39], v33, s[16:19], s56 offen sc1
    s_waitcnt vmcnt(1)
    s_barrier
    s_waitcnt vmcnt(0)
    s_mov_b32 s63, 0
L_spin0:
    v_cmp_ne_u64 vcc, s[30:31], v[38:39]
    s_nop 1
    s_cmp_eq_u64 vcc, 0
    s_cbranch_scc1 L_spin0_ok
    s_add_u32 s63, s63, 1
    s_cmp_gt_u32 s63, 0x40000
    s_cbranch_scc1 L_spin0_ok
    s_sleep 2
    s_mov_b32 s56, 11698176
    s_mov_b32 s58, -1
    s_mov_b32 s59, 15
    s_mov_b64 exec, s[58:59]
    buffer_load_dwordx4 v[36:39], v33, s[16:19], s56 offen sc1
    s_waitcnt vmcnt(0)
    s_branch L_spin0
L_spin0_ok:
    ds_write_b64 v34, v[36:37]
    ds_write_b32 v35, v37
    s_mov_b64 exec, -1
    s_waitcnt lgkmcnt(0)
    s_mov_b32 s56, 11730952
    buffer_load_dwordx2 v[40:41], v32, s[16:19], s56 offen sc1
    s_barrier
    s_barrier
    s_waitcnt vmcnt(0)
    s_mov_b32 s63, 0
L_spin1:
    v_cmp_ne_u64 vcc, s[30:31], v[40:41]
    s_nop 1
    s_cmp_eq_u64 vcc, 0
    s_cbranch_scc1 L_spin1_ok
    s_add_u32 s63, s63, 1
    s_cmp_gt_u32 s63, 0x40000
    s_cbranch_scc1 L_spin1_ok
    s_sleep 2
    s_mov_b32 s56, 11730952
    buffer_load_dwordx2 v[40:41], v32, s[16:19], s56 offen sc1
    s_waitcnt vmcnt(0)
    s_branch L_spin1
L_spin1_ok:
    s_mov_b32 s72, 0
    s_add_u32 m0, s72, s74
    s_add_u32 s56, s71, 4096
    buffer_load_dwordx4 v26, s[16:19], s71 offen offset:0 sc1 lds
    buffer_load_dwordx4 v26, s[16:19], s71 offen offset:1024 sc1 lds
    buffer_load_dwordx4 v26, s[16:19], s71 offen offset:2048 sc1 lds
    buffer_load_dwordx4 v26, s[16:19], s71 offen offset:3072 sc1 lds
    s_add_u32 m0, m0, 4096
    s_add_u32 s71, s71, 20480
    buffer_load_dwordx4 v26, s[16:19], s56 offen sc1 lds
    s_mov_b32 s72, 36864
    s_add_u32 m0, s72, s74
    s_add_u32 s56, s71, 4096
    buffer_load_dwordx4 v26, s[16:19], s71 offen offset:0 sc1 lds
    buffer_load_dwordx4 v26, s[16:19], s71 offen offset:1024 sc1 lds
    buffer_load_dwordx4 v26, s[16:19], s71 offen offset:2048 sc1 lds
    buffer_load_dwordx4 v26, s[16:19], s71 offen offset:3072 sc1 lds
    s_add_u32 m0, m0, 4096
    s_add_u32 s71, s71, 20480
    buffer_load_dwordx4 v26, s[16:19], s56 offen sc1 lds
    s_mov_b64 exec, 0xff
    buffer_load_dwordx2 v[42:43], v25, s[16:19], s76 offen offset:1024 sc1
    s_mov_b64 exec, -1
    s_barrier
    s_waitcnt vmcnt(0)
    s_mov_b64 exec, 0xff
    s_mov_b32 s63, 0
L_spin2:
    v_cmp_ne_u64 vcc, s[30:31], v[42:43]
    s_nop 1
    s_cmp_eq_u64 vcc, 0
    s_cbranch_scc1 L_spin2_ok
    s_add_u32 s63, s63, 1
    s_cmp_gt_u32 s63, 0x40000
    s_cbranch_scc1 L_spin2_ok
    s_sleep 2
    s_mov_b64 exec, 0xff
    buffer_load_dwordx2 v[42:43], v25, s[16:19], s76 offen offset:1024 sc1
    s_waitcnt vmcnt(0)
    s_branch L_spin2
L_spin2_ok:
    s_mov_b64 exec, -1
    s_mov_b32 s72, 0
    s_add_u32 m0, s72, s73
    s_nop 0
    buffer_load_dwordx4 v26, s[16:19], s70 offen offset:0 sc1 lds
    buffer_load_dwordx4 v26, s[16:19], s70 offen offset:1024 sc1 lds
    buffer_load_dwordx4 v26, s[16:19], s70 offen offset:2048 sc1 lds
    buffer_load_dwordx4 v26, s[16:19], s70 offen offset:3072 sc1 lds
    s_add_u32 s70, s70, 4096
    s_mov_b32 s72, 36864
    s_add_u32 m0, s72, s73
    s_nop 0
    buffer_load_dwordx4 v26, s[16:19], s70 offen offset:0 sc1 lds
    buffer_load_dwordx4 v26, s[16:19], s70 offen offset:1024 sc1 lds
    buffer_load_dwordx4 v26, s[16:19], s70 offen offset:2048 sc1 lds
    buffer_load_dwordx4 v26, s[16:19], s70 offen offset:3072 sc1 lds
    s_add_u32 s70, s70, 4096
    s_mov_b32 s72, 73728
    s_mov_b32 s20, s38
    s_and_b32 s21, s39, 0xffff
    s_mov_b32 s22, 1280
    s_mov_b32 s23, 0x00020000
    v_mul_u32_u24 v16, 26, v1
    v_lshrrev_b32 v16, 8, v16
    v_mul_u32_u24 v17, 10, v16
    v_sub_u32 v17, v1, v17
    v_mul_u32_u24 v16, 2560, v16
    v_lshl_add_u32 v16, v17, 4, v16
    v_lshlrev_b32 v17, 3, v1
    v_add_u32 v17, 157696, v17
    s_mov_b32 s54, -1
    s_mov_b32 s55, 0xff
    s_waitcnt vmcnt(4)
    s_barrier
    s_add_u32 m0, s72, s74
    s_add_u32 s56, s71, 4096
    buffer_load_dwordx4 v26, s[16:19], s71 offen offset:0 sc1 lds
    buffer_load_dwordx4 v26, s[16:19], s71 offen offset:1024 sc1 lds
    buffer_load_dwordx4 v26, s[16:19], s71 offen offset:2048 sc1 lds
    buffer_load_dwordx4 v26, s[16:19], s71 offen offset:3072 sc1 lds
    s_add_u32 m0, m0, 4096
    s_add_u32 s71, s71, 20480
    buffer_load_dwordx4 v26, s[16:19], s56 offen sc1 lds
    s_add_u32 m0, s72, s73
    s_nop 0
    buffer_load_dwordx4 v26, s[16:19], s70 offen offset:0 sc1 lds
    buffer_load_dwordx4 v26, s[16:19], s70 offen offset:1024 sc1 lds
    buffer_load_dwordx4 v26, s[16:19], s70 offen offset:2048 sc1 lds
    buffer_load_dwordx4 v26, s[16:19], s70 offen offset:3072 sc1 lds
    s_add_u32 s70, s70, 4096
    s_add_u32 s72, s72, 36864
    s_cmp_eq_u32 s72, 147456
    s_cselect_b32 s72, 0, s72
    s_add_u32 m0, s72, s74
    s_add_u32 s56, s71, 4096
    buffer_load_dwordx4 v26, s[16:19], s71 offen offset:0 sc1 lds
    buffer_load_dwordx4 v26, s[16:19], s71 offen offset:1024 sc1 lds
    buffer_load_dwordx4 v26, s[16:19], s71 offen offset:2048 sc1 lds
    buffer_load_dwordx4 v26, s[16:19], s71 offen offset:3072 sc1 lds
    s_add_u32 m0, m0, 4096
    s_add_u32 s71, s71, 20480
    buffer_load_dwordx4 v26, s[16:19], s56 offen sc1 lds
    s_add_u32 m0, s72, s73
    s_nop 0
    buffer_load_dwordx4 v26, s[16:19], s70 offen offset:0 sc1 lds
    buffer_load_dwordx4 v26, s[16:19], s70 offen offset:1024 sc1 lds
    buffer_load_dwordx4 v26, s[16:19], s70 offen offset:2048 sc1 lds
    buffer_load_dwordx4 v26, s[16:19], s70 offen offset:3072 sc1 lds
    s_add_u32 s70, s70, 4096
    s_add_u32 s72, s72, 36864
    s_cmp_eq_u32 s72, 147456
    s_cselect_b32 s72, 0, s72
    s_bfe_u32 s56, s2, 0x10001
    s_lshl_b32 s57, s43, 1
    s_add_u32 s56, s56, s57
    s_lshl_b32 s56, s56, 6
    s_lshr_b32 s57, s41, 1
    s_lshl_b32 s57, s57, 5
    s_add_u32 s56, s56, s57
    s_and_b32 s57, s41, 1
    s_add_u32 s56, s56, s57
    s_mul_i32 s56, s56, 1280
    s_and_b32 s57, s2, 1
    s_lshl_b32 s57, s57, 2
    s_bfe_u32 s58, s2, 0x20003
    s_add_u32 s57, s57, s58
    s_mul_i32 s57, s57, 160
    s_add_u32 s56, s56, s57
    s_mul_i32 s58, s41, 2560
    s_add_u32 m0, s58, 147456
    s_mov_b64 exec, s[54:55]
    s_add_u32 s60, s56, 0
    buffer_load_dwordx4 v16, s[8:11], s60 offen offset:0 lds
    s_add_u32 s60, s56, 9600
    buffer_load_dwordx4 v16, s[8:11], s60 offen offset:640 lds
    s_add_u32 s60, s56, 19200
    buffer_load_dwordx4 v16, s[8:11], s60 offen offset:1280 lds
    s_add_u32 s60, s56, 28800
    buffer_load_dwordx4 v16, s[8:11], s60 offen offset:1920 lds
    buffer_load_dword v36, v27, s[20:23], s57 offen
    s_mov_b64 exec, -1
    s_waitcnt vmcnt(23)
    s_barrier
    s_add_u32 m0, s72, s74
    s_add_u32 s56, s71, 4096
    buffer_load_dwordx4 v26, s[16:19], s71 offen offset:0 sc1 lds
    buffer_load_dwordx4 v26, s[16:19], s71 offen offset:1024 sc1 lds
    buffer_load_dwordx4 v26, s[16:19], s71 offen offset:2048 sc1 lds
    buffer_load_dwordx4 v26, s[16:19], s71 offen offset:3072 sc1 lds
    s_add_u32 m0, m0, 4096
    s_add_u32 s71, s71, 20480
    buffer_load_dwordx4 v26, s[16:19], s56 offen sc1 lds
    s_add_u32 m0, s72, s73
    s_nop 0
    buffer_load_dwordx4 v26, s[16:19], s70 offen offset:0 sc1 lds
    buffer_load_dwordx4 v26, s[16:19], s70 offen offset:1024 sc1 lds
    buffer_load_dwordx4 v26, s[16:19], s70 offen offset:2048 sc1 lds
    buffer_load_dwordx4 v26, s[16:19], s70 offen offset:3072 sc1 lds
    s_add_u32 s70, s70, 4096
    s_add_u32 s72, s72, 36864
    s_cmp_eq_u32 s72, 147456
    s_cselect_b32 s72, 0, s72
    s_waitcnt vmcnt(23)
    s_barrier
    s_add_u32 m0, s72, s74
    s_add_u32 s56, s71, 4096
    buffer_load_dwordx4 v26, s[16:19], s71 offen offset:0 sc1 lds
    buffer_load_dwordx4 v26, s[16:19], s71 offen offset:1024 sc1 lds
    buffer_load_dwordx4 v26, s[16:19], s71 offen offset:2048 sc1 lds
    buffer_load_dwordx4 v26, s[16:19], s71 offen offset:3072 sc1 lds
    s_add_u32 m0, m0, 4096
    s_add_u32 s71, s71, 20480
    buffer_load_dwordx4 v26, s[16:19], s56 offen sc1 lds
    s_add_u32 m0, s72, s73
    s_nop 0
    buffer_load_dwordx4 v26, s[16:19], s70 offen offset:0 sc1 lds
    buffer_load_dwordx4 v26, s[16:19], s70 offen offset:1024 sc1 lds
    buffer_load_dwordx4 v26, s[16:19], s70 offen offset:2048 sc1 lds
    buffer_load_dwordx4 v26, s[16:19], s70 offen offset:3072 sc1 lds
    s_add_u32 s70, s70, 4096
    s_add_u32 s72, s72, 36864
    s_cmp_eq_u32 s72, 147456
    s_cselect_b32 s72, 0, s72
    s_waitcnt vmcnt(23)
    s_barrier
    s_add_u32 m0, s72, s74
    s_add_u32 s56, s71, 4096
    buffer_load_dwordx4 v26, s[16:19], s71 offen offset:0 sc1 lds
    buffer_load_dwordx4 v26, s[16:19], s71 offen offset:1024 sc1 lds
    buffer_load_dwordx4 v26, s[16:19], s71 offen offset:2048 sc1 lds
    buffer_load_dwordx4 v26, s[16:19], s71 offen offset:3072 sc1 lds
    s_add_u32 m0, m0, 4096
    s_add_u32 s71, s71, 20480
    buffer_load_dwordx4 v26, s[16:19], s56 offen sc1 lds
    s_add_u32 m0, s72, s73
    s_nop 0
    buffer_load_dwordx4 v26, s[16:19], s70 offen offset:0 sc1 lds
    buffer_load_dwordx4 v26, s[16:19], s70 offen offset:1024 sc1 lds
    buffer_load_dwordx4 v26, s[16:19], s70 offen offset:2048 sc1 lds
    buffer_load_dwordx4 v26, s[16:19], s70 offen offset:3072 sc1 lds
    s_add_u32 s70, s70, 4096
    s_add_u32 s72, s72, 36864
    s_cmp_eq_u32 s72, 147456
    s_cselect_b32 s72, 0, s72
    s_waitcnt vmcnt(18)
    v_lshlrev_b32 v20, 16, v36
    v_and_b32 v21, 0xffff0000, v36
    s_mov_b64 exec, s[54:55]
    ds_write_b64 v17, v[20:21]
    s_mov_b64 exec, -1
    s_waitcnt lgkmcnt(0)
    s_barrier
    s_add_u32 m0, s72, s74
    s_add_u32 s56, s71, 4096
    buffer_load_dwordx4 v26, s[16:19], s71 offen offset:0 sc1 lds
    buffer_load_dwordx4 v26, s[16:19], s71 offen offset:1024 sc1 lds
    buffer_load_dwordx4 v26, s[16:19], s71 offen offset:2048 sc1 lds
    buffer_load_dwordx4 v26, s[16:19], s71 offen offset:3072 sc1 lds
    s_add_u32 m0, m0, 4096
    s_add_u32 s71, s71, 20480
    buffer_load_dwordx4 v26, s[16:19], s56 offen sc1 lds
    s_add_u32 m0, s72, s73
    s_nop 0
    buffer_load_dwordx4 v26, s[16:19], s70 offen offset:0 sc1 lds
    buffer_load_dwordx4 v26, s[16:19], s70 offen offset:1024 sc1 lds
    buffer_load_dwordx4 v26, s[16:19], s70 offen offset:2048 sc1 lds
    buffer_load_dwordx4 v26, s[16:19], s70 offen offset:3072 sc1 lds
    s_add_u32 s70, s70, 4096
    s_add_u32 s72, s72, 36864
    s_cmp_eq_u32 s72, 147456
    s_cselect_b32 s72, 0, s72
    s_mov_b32 s48, 5
L_ldQ_p2b:
    s_waitcnt vmcnt(18)
    s_barrier
    s_add_u32 m0, s72, s74
    s_add_u32 s56, s71, 4096
    buffer_load_dwordx4 v26, s[16:19], s71 offen offset:0 sc1 lds
    buffer_load_dwordx4 v26, s[16:19], s71 offen offset:1024 sc1 lds
    buffer_load_dwordx4 v26, s[16:19], s71 offen offset:2048 sc1 lds
    buffer_load_dwordx4 v26, s[16:19], s71 offen offset:3072 sc1 lds
    s_add_u32 m0, m0, 4096
    s_add_u32 s71, s71, 20480
    buffer_load_dwordx4 v26, s[16:19], s56 offen sc1 lds
    s_add_u32 m0, s72, s73
    s_nop 0
    buffer_load_dwordx4 v26, s[16:19], s70 offen offset:0 sc1 lds
    buffer_load_dwordx4 v26, s[16:19], s70 offen offset:1024 sc1 lds
    buffer_load_dwordx4 v26, s[16:19], s70 offen offset:2048 sc1 lds
    buffer_load_dwordx4 v26, s[16:19], s70 offen offset:3072 sc1 lds
    s_add_u32 s70, s70, 4096
    s_add_u32 s72, s72, 36864
    s_cmp_eq_u32 s72, 147456
    s_cselect_b32 s72, 0, s72
    s_add_u32 s48, s48, 1
    s_cmp_lt_u32 s48, 14
    s_cbranch_scc1 L_ldQ_p2b
    s_waitcnt vmcnt(18)
    s_barrier
    s_waitcnt vmcnt(9)
    s_barrier
    s_waitcnt vmcnt(0)
    s_barrier
    s_mov_b64 exec, -1
    s_endpgm
L_ldF:
    v_cmp_le_u32 vcc, 26, v1
    v_mov_b32 v19, 0
    v_mov_b32 v20, 2656
    v_cndmask_b32 v19, v19, v20, vcc
    v_lshl_add_u32 v19, v1, 4, v19
    s_mul_i32 s56, s41, 24576
    s_mul_i32 s57, s42, 384
    s_add_u32 s56, s56, s57
    v_add_u32 v6, s56, v19
    v_add_u32 v7, 5312, v6
    v_add_u32 v8, 10624, v6
    v_add_u32 v9, 15936, v6
    s_mul_i32 s49, s41, 3456
    s_lshl_b32 s50, s41, 12
    s_add_u32 s50, s50, 27648
    s_mov_b32 s52, 0xfcffffff
    s_mov_b32 s53, 0x0003ffff
    s_waitcnt lgkmcnt(0)
    s_mov_b32 s8, s4
    s_and_b32 s9, s5, 0xffff
    s_mov_b32 s10, 2621440
    s_mov_b32 s11, 0x00020000
    s_mov_b32 s12, s32
    s_and_b32 s13, s33, 0xffff
    s_mov_b32 s14, 1966080
    s_mov_b32 s15, 0x00020000
    s_mov_b32 s44, 0
    s_add_u32 s30, s68, 11796480
    s_addc_u32 s31, s69, 0
    s_load_dwordx2 s[30:31], s[30:31], 0
    s_add_u32 m0, s44, s50
    s_add_u32 s56, s47, 1280
    buffer_load_dwordx4 v2, s[8:11], s47 offen lds
    buffer_load_dwordx4 v3, s[8:11], s47 offen offset:1024 lds
    s_add_u32 m0, m0, 2048
    s_nop 0
    buffer_load_dwordx4 v2, s[8:11], s56 offen lds
    buffer_load_dwordx4 v3, s[8:11], s56 offen offset:1024 lds
    s_add_u32 m0, s44, s49
    s_mov_b64 exec, s[52:53]
    buffer_load_dwordx4 v6, s[12:15], s46 offen offset:0 lds
    buffer_load_dwordx4 v7, s[12:15], s46 offen offset:832 lds
    buffer_load_dwordx4 v8, s[12:15], s46 offen offset:1664 lds
    buffer_load_dwordx4 v9, s[12:15], s46 offen offset:2496 lds
    s_add_u32 m0, m0, 13824
    s_add_u32 s56, s46, 98304
    buffer_load_dwordx4 v6, s[12:15], s56 offen offset:0 lds
    buffer_load_dwordx4 v7, s[12:15], s56 offen offset:832 lds
    buffer_load_dwordx4 v8, s[12:15], s56 offen offset:1664 lds
    buffer_load_dwordx4 v9, s[12:15], s56 offen offset:2496 lds
    s_mov_b64 exec, -1
    s_add_u32 s46, s46, 196608
    s_add_u32 s47, s47, 128
    s_add_u32 s44, s44, 44032
    s_cmp_eq_u32 s44, 132096
    s_cselect_b32 s44, 0, s44
    s_add_u32 m0, s44, s50
    s_add_u32 s56, s47, 1280
    buffer_load_dwordx4 v2, s[8:11], s47 offen lds
    buffer_load_dwordx4 v3, s[8:11], s47 offen offset:1024 lds
    s_add_u32 m0, m0, 2048
    s_nop 0
    buffer_load_dwordx4 v2, s[8:11], s56 offen lds
    buffer_load_dwordx4 v3, s[8:11], s56 offen offset:1024 lds
    s_add_u32 m0, s44, s49
    s_mov_b64 exec, s[52:53]
    buffer_load_dwordx4 v6, s[12:15], s46 offen offset:0 lds
    buffer_load_dwordx4 v7, s[12:15], s46 offen offset:832 lds
    buffer_load_dwordx4 v8, s[12:15], s46 offen offset:1664 lds
    buffer_load_dwordx4 v9, s[12:15], s46 offen offset:2496 lds
    s_add_u32 m0, m0, 13824
    s_add_u32 s56, s46, 98304
    buffer_load_dwordx4 v6, s[12:15], s56 offen offset:0 lds
    buffer_load_dwordx4 v7, s[12:15], s56 offen offset:832 lds
    buffer_load_dwordx4 v8, s[12:15], s56 offen offset:1664 lds
    buffer_load_dwordx4 v9, s[12:15], s56 offen offset:2496 lds
    s_mov_b64 exec, -1
    s_add_u32 s46, s46, 196608
    s_add_u32 s47, s47, 128
    s_add_u32 s44, s44, 44032
    s_cmp_eq_u32 s44, 132096
    s_cselect_b32 s44, 0, s44
    s_mov_b32 s16, s68
    s_and_b32 s17, s69, 0xffff
    s_mov_b32 s18, 11796608
    s_mov_b32 s19, 0x00020000
    s_waitcnt vmcnt(12) lgkmcnt(0)
    s_barrier
    s_add_u32 m0, s44, s50
    s_add_u32 s56, s47, 1280
    buffer_load_dwordx4 v2, s[8:11], s47 offen lds
    buffer_load_dwordx4 v3, s[8:11], s47 offen offset:1024 lds
    s_add_u32 m0, m0, 2048
    s_nop 0
    buffer_load_dwordx4 v2, s[8:11], s56 offen lds
    buffer_load_dwordx4 v3, s[8:11], s56 offen offset:1024 lds
    s_add_u32 m0, s44, s49
    s_mov_b64 exec, s[52:53]
    buffer_load_dwordx4 v6, s[12:15], s46 offen offset:0 lds
    buffer_load_dwordx4 v7, s[12:15], s46 offen offset:832 lds
    buffer_load_dwordx4 v8, s[12:15], s46 offen offset:1664 lds
    buffer_load_dwordx4 v9, s[12:15], s46 offen offset:2496 lds
    s_add_u32 m0, m0, 13824
    s_add_u32 s56, s46, 98304
    buffer_load_dwordx4 v6, s[12:15], s56 offen offset:0 lds
    buffer_load_dwordx4 v7, s[12:15], s56 offen offset:832 lds
    buffer_load_dwordx4 v8, s[12:15], s56 offen offset:1664 lds
    buffer_load_dwordx4 v9, s[12:15], s56 offen offset:2496 lds
    s_mov_b64 exec, -1
    s_add_u32 s46, s46, 196608
    s_add_u32 s47, s47, 128
    s_add_u32 s44, s44, 44032
    s_cmp_eq_u32 s44, 132096
    s_cselect_b32 s44, 0, s44
    v_lshlrev_b32 v26, 4, v1
    v_lshlrev_b32 v25, 7, v1
    v_lshlrev_b32 v27, 2, v1
    s_add_u32 s30, s30, 1
    s_addc_u32 s31, s31, 0
    v_lshrrev_b32 v32, 2, v1
    v_lshlrev_b32 v32, 4, v32
    v_bfe_u32 v16, v1, 1, 1
    v_lshl_add_u32 v32, v16, 2, v32
    v_and_b32 v16, 1, v1
    v_add_u32 v32, v32, v16
    s_and_b32 s56, s2, 1
    s_lshl_b32 s56, s56, 1
    s_add_u32 s56, s56, 8
    v_add_lshl_u32 v32, v32, s56, 7
    s_mul_i32 s56, s41, 32
    v_add_u32 v16, s56, v1
    s_lshl_b32 s56, s43, 7
    v_add_u32 v17, s56, v16
    v_max_i32 v17, 0, v17
    v_lshlrev_b32 v33, 4, v17
    v_ashrrev_i32 v17, 5, v16
    v_and_b32 v18, 1, v16
    v_lshl_add_u32 v17, v17, 1, v18
    v_bfe_u32 v19, v16, 1, 4
    v_lshl_add_u32 v17, v17, 4, v19
    v_lshlrev_b32 v34, 3, v17
    v_add_u32 v34, 158720, v34
    s_bfe_u32 s56, s2, 0x10001
    s_lshl_b32 s57, s43, 1
    s_add_u32 s56, s56, s57
    s_lshl_b32 s76, s43, 11
    s_add_u32 s76, s76, 11730944
    s_lshl_b32 s70, s56, 2
    s_add_u32 s70, s70, s41
    s_mul_i32 s70, s70, 69632
    s_and_b32 s56, s2, 1
    s_lshl_b32 s56, s56, 2
    s_bfe_u32 s57, s2, 0x20003
    s_add_u32 s56, s56, s57
    s_mul_i32 s71, s56, 68
    s_add_u32 s71, s71, s41
    s_mul_i32 s71, s71, 5120
    s_add_u32 s71, s71, 8912896
    s_mul_i32 s74, s41, 5120
    s_lshl_b32 s73, s41, 12
    s_add_u32 s73, s73, 20480
    s_mov_b32 s75, 1
    s_mov_b32 s48, 0
L_ldF_loop:
    s_waitcnt vmcnt(12)
    s_barrier
    s_add_u32 m0, s44, s50
    s_add_u32 s56, s47, 1280
    buffer_load_dwordx4 v2, s[8:11], s47 offen lds
    buffer_load_dwordx4 v3, s[8:11], s47 offen offset:1024 lds
    s_add_u32 m0, m0, 2048
    s_nop 0
    buffer_load_dwordx4 v2, s[8:11], s56 offen lds
    buffer_load_dwordx4 v3, s[8:11], s56 offen offset:1024 lds
    s_add_u32 m0, s44, s49
    s_mov_b64 exec, s[52:53]
    buffer_load_dwordx4 v6, s[12:15], s46 offen offset:0 lds
    buffer_load_dwordx4 v7, s[12:15], s46 offen offset:832 lds
    buffer_load_dwordx4 v8, s[12:15], s46 offen offset:1664 lds
    buffer_load_dwordx4 v9, s[12:15], s46 offen offset:2496 lds
    s_add_u32 m0, m0, 13824
    s_add_u32 s56, s46, 98304
    buffer_load_dwordx4 v6, s[12:15], s56 offen offset:0 lds
    buffer_load_dwordx4 v7, s[12:15], s56 offen offset:832 lds
    buffer_load_dwordx4 v8, s[12:15], s56 offen offset:1664 lds
    buffer_load_dwordx4 v9, s[12:15], s56 offen offset:2496 lds
    s_mov_b64 exec, -1
    s_add_u32 s46, s46, 196608
    s_add_u32 s47, s47, 128
    s_add_u32 s44, s44, 44032
    s_cmp_eq_u32 s44, 132096
    s_cselect_b32 s44, 0, s44
    s_add_u32 s48, s48, 1
    s_cmp_lt_u32 s48, 7
    s_cbranch_scc1 L_ldF_loop
    s_waitcnt vmcnt(12)
    s_barrier
    s_mov_b32 s56, 11698176
    s_mov_b32 s58, -1
    s_mov_b32 s59, 0
    s_mov_b64 exec, s[58:59]
    buffer_load_dwordx4 v[36:39], v33, s[16:19], s56 offen sc1
    s_waitcnt vmcnt(1)
    s_barrier
    s_waitcnt vmcnt(0)
    s_mov_b32 s63, 0
L_spin3:
    v_cmp_ne_u64 vcc, s[30:31], v[38:39]
    s_nop 1
    s_cmp_eq_u64 vcc, 0
    s_cbranch_scc1 L_spin3_ok
    s_add_u32 s63, s63, 1
    s_cmp_gt_u32 s63, 0x40000
    s_cbranch_scc1 L_spin3_ok
    s_sleep 2
    s_mov_b32 s56, 11698176
    s_mov_b32 s58, -1
    s_mov_b32 s59, 0
    s_mov_b64 exec, s[58:59]
    buffer_load_dwordx4 v[36:39], v33, s[16:19], s56 offen sc1
    s_waitcnt vmcnt(0)
    s_branch L_spin3
L_spin3_ok:
    ds_write_b64 v34, v[36:37]
    s_mov_b64 exec, -1
    s_waitcnt lgkmcnt(0)
    s_mov_b32 s56, 11730952
    buffer_load_dwordx2 v[40:41], v32, s[16:19], s56 offen sc1
    s_barrier
    s_barrier
    s_waitcnt vmcnt(0)
    s_mov_b32 s63, 0
L_spin4:
    v_cmp_ne_u64 vcc, s[30:31], v[40:41]
    s_nop 1
    s_cmp_eq_u64 vcc, 0
    s_cbranch_scc1 L_spin4_ok
    s_add_u32 s63, s63, 1
    s_cmp_gt_u32 s63, 0x40000
    s_cbranch_scc1 L_spin4_ok
    s_sleep 2
    s_mov_b32 s56, 11730952
    buffer_load_dwordx2 v[40:41], v32, s[16:19], s56 offen sc1
    s_waitcnt vmcnt(0)
    s_branch L_spin4
L_spin4_ok:
    s_mov_b32 s72, 0
    s_add_u32 m0, s72, s74
    s_add_u32 s56, s71, 4096
    buffer_load_dwordx4 v26, s[16:19], s71 offen offset:0 sc1 lds
    buffer_load_dwordx4 v26, s[16:19], s71 offen offset:1024 sc1 lds
    buffer_load_dwordx4 v26, s[16:19], s71 offen offset:2048 sc1 lds
    buffer_load_dwordx4 v26, s[16:19], s71 offen offset:3072 sc1 lds
    s_add_u32 m0, m0, 4096
    s_add_u32 s71, s71, 20480
    buffer_load_dwordx4 v26, s[16:19], s56 offen sc1 lds
    s_mov_b32 s72, 36864
    s_add_u32 m0, s72, s74
    s_add_u32 s56, s71, 4096
    buffer_load_dwordx4 v26, s[16:19], s71 offen offset:0 sc1 lds
    buffer_load_dwordx4 v26, s[16:19], s71 offen offset:1024 sc1 lds
    buffer_load_dwordx4 v26, s[16:19], s71 offen offset:2048 sc1 lds
    buffer_load_dwordx4 v26, s[16:19], s71 offen offset:3072 sc1 lds
    s_add_u32 m0, m0, 4096
    s_add_u32 s71, s71, 20480
    buffer_load_dwordx4 v26, s[16:19], s56 offen sc1 lds
    s_barrier
    s_lshl_b32 s56, s42, 7
    s_add_u32 s56, s56, s76
    s_cmp_eq_u32 s41, 0
    s_cselect_b32 s56, s56, 0x7f000000
    v_mov_b32 v16, s30
    v_mov_b32 v17, s31
    v_mov_b32 v18, 0
    s_mov_b64 exec, 1
    buffer_store_dwordx2 v[16:17], v18, s[16:19], s56 offen offset:1024 sc1
    s_mov_b64 exec, -1
    s_mov_b32 s72, 73728
    s_add_u32 m0, s72, s74
    s_add_u32 s56, s71, 4096
    buffer_load_dwordx4 v26, s[16:19], s71 offen offset:0 sc1 lds
    buffer_load_dwordx4 v26, s[16:19], s71 offen offset:1024 sc1 lds
    buffer_load_dwordx4 v26, s[16:19], s71 offen offset:2048 sc1 lds
    buffer_load_dwordx4 v26, s[16:19], s71 offen offset:3072 sc1 lds
    s_add_u32 m0, m0, 4096
    s_add_u32 s71, s71, 20480
    buffer_load_dwordx4 v26, s[16:19], s56 offen sc1 lds
    s_mov_b32 s72, 110592
    s_add_u32 m0, s72, s74
    s_add_u32 s56, s71, 4096
    buffer_load_dwordx4 v26, s[16:19], s71 offen offset:0 sc1 lds
    buffer_load_dwordx4 v26, s[16:19], s71 offen offset:1024 sc1 lds
    buffer_load_dwordx4 v26, s[16:19], s71 offen offset:2048 sc1 lds
    buffer_load_dwordx4 v26, s[16:19], s71 offen offset:3072 sc1 lds
    s_add_u32 m0, m0, 4096
    s_add_u32 s71, s71, 20480
    buffer_load_dwordx4 v26, s[16:19], s56 offen sc1 lds
    s_mov_b64 exec, 0xff
    buffer_load_dwordx2 v[42:43], v25, s[16:19], s76 offen offset:1024 sc1
    s_waitcnt vmcnt(0)
    s_mov_b64 exec, 0xff
    s_mov_b32 s63, 0
L_spin5:
    v_cmp_ne_u64 vcc, s[30:31], v[42:43]
    s_nop 1
    s_cmp_eq_u64 vcc, 0
    s_cbranch_scc1 L_spin5_ok
    s_add_u32 s63, s63, 1
    s_cmp_gt_u32 s63, 0x40000
    s_cbranch_scc1 L_spin5_ok
    s_sleep 2
    s_mov_b64 exec, 0xff
    buffer_load_dwordx2 v[42:43], v25, s[16:19], s76 offen offset:1024 sc1
    s_waitcnt vmcnt(0)
    s_branch L_spin5
L_spin5_ok:
    s_mov_b64 exec, -1
    s_mov_b32 s72, 0
    s_add_u32 m0, s72, s73
    s_nop 0
    buffer_load_dwordx4 v26, s[16:19], s70 offen offset:0 sc1 lds
    buffer_load_dwordx4 v26, s[16:19], s70 offen offset:1024 sc1 lds
    buffer_load_dwordx4 v26, s[16:19], s70 offen offset:2048 sc1 lds
    buffer_load_dwordx4 v26, s[16:19], s70 offen offset:3072 sc1 lds
    s_add_u32 s70, s70, 4096
    s_mov_b32 s72, 36864
    s_add_u32 m0, s72, s73
    s_nop 0
    buffer_load_dwordx4 v26, s[16:19], s70 offen offset:0 sc1 lds
    buffer_load_dwordx4 v26, s[16:19], s70 offen offset:1024 sc1 lds
    buffer_load_dwordx4 v26, s[16:19], s70 offen offset:2048 sc1 lds
    buffer_load_dwordx4 v26, s[16:19], s70 offen offset:3072 sc1 lds
    s_add_u32 s70, s70, 4096
    s_mov_b32 s72, 73728
    s_add_u32 m0, s72, s73
    s_nop 0
    buffer_load_dwordx4 v26, s[16:19], s70 offen offset:0 sc1 lds
    buffer_load_dwordx4 v26, s[16:19], s70 offen offset:1024 sc1 lds
    buffer_load_dwordx4 v26, s[16:19], s70 offen offset:2048 sc1 lds
    buffer_load_dwordx4 v26, s[16:19], s70 offen offset:3072 sc1 lds
    s_add_u32 s70, s70, 4096
    s_mov_b32 s72, 110592
    s_add_u32 m0, s72, s73
    s_nop 0
    buffer_load_dwordx4 v26, s[16:19], s70 offen offset:0 sc1 lds
    buffer_load_dwordx4 v26, s[16:19], s70 offen offset:1024 sc1 lds
    buffer_load_dwordx4 v26, s[16:19], s70 offen offset:2048 sc1 lds
    buffer_load_dwordx4 v26, s[16:19], s70 offen offset:3072 sc1 lds
    s_add_u32 s70, s70, 4096
    s_mov_b32 s72, 0
    s_mov_b32 s20, s38
    s_and_b32 s21, s39, 0xffff
    s_mov_b32 s22, 1280
    s_mov_b32 s23, 0x00020000
    v_mul_u32_u24 v16, 26, v1
    v_lshrrev_b32 v16, 8, v16
    v_mul_u32_u24 v17, 10, v16
    v_sub_u32 v17, v1, v17
    v_mul_u32_u24 v16, 2560, v16
    v_lshl_add_u32 v16, v17, 4, v16
    v_lshlrev_b32 v17, 3, v1
    v_add_u32 v17, 157696, v17
    s_mov_b32 s54, -1
    s_mov_b32 s55, 0xff
    s_waitcnt vmcnt(12)
    s_barrier
    s_bfe_u32 s56, s2, 0x10001
    s_lshl_b32 s57, s43, 1
    s_add_u32 s56, s56, s57
    s_lshl_b32 s56, s56, 6
    s_lshr_b32 s57, s41, 1
    s_lshl_b32 s57, s57, 5
    s_add_u32 s56, s56, s57
    s_and_b32 s57, s41, 1
    s_add_u32 s56, s56, s57
    s_mul_i32 s56, s56, 1280
    s_and_b32 s57, s2, 1
    s_lshl_b32 s57, s57, 2
    s_bfe_u32 s58, s2, 0x20003
    s_add_u32 s57, s57, s58
    s_mul_i32 s57, s57, 160
    s_add_u32 s56, s56, s57
    s_mul_i32 s58, s41, 2560
    s_add_u32 m0, s58, 147456
    s_mov_b64 exec, s[54:55]
    s_add_u32 s60, s56, 0
    buffer_load_dwordx4 v16, s[8:11], s60 offen offset:0 lds
    s_add_u32 s60, s56, 9600
    buffer_load_dwordx4 v16, s[8:11], s60 offen offset:640 lds
    s_add_u32 s60, s56, 19200
    buffer_load_dwordx4 v16, s[8:11], s60 offen offset:1280 lds
    s_add_u32 s60, s56, 28800
    buffer_load_dwordx4 v16, s[8:11], s60 offen offset:1920 lds
    buffer_load_dword v36, v27, s[20:23], s57 offen
    s_mov_b64 exec, -1
    s_waitcnt vmcnt(13)
    s_barrier
    s_add_u32 m0, s72, s74
    s_add_u32 s56, s71, 4096
    buffer_load_dwordx4 v26, s[16:19], s71 offen offset:0 sc1 lds
    buffer_load_dwordx4 v26, s[16:19], s71 offen offset:1024 sc1 lds
    buffer_load_dwordx4 v26, s[16:19], s71 offen offset:2048 sc1 lds
    buffer_load_dwordx4 v26, s[16:19], s71 offen offset:3072 sc1 lds
    s_add_u32 m0, m0, 4096
    s_add_u32 s71, s71, 20480
    buffer_load_dwordx4 v26, s[16:19], s56 offen sc1 lds
    s_add_u32 m0, s72, s73
    s_nop 0
    buffer_load_dwordx4 v26, s[16:19], s70 offen offset:0 sc1 lds
    buffer_load_dwordx4 v26, s[16:19], s70 offen offset:1024 sc1 lds
    buffer_load_dwordx4 v26, s[16:19], s70 offen offset:2048 sc1 lds
    buffer_load_dwordx4 v26, s[16:19], s70 offen offset:3072 sc1 lds
    s_add_u32 s70, s70, 4096
    s_add_u32 s72, s72, 36864
    s_cmp_eq_u32 s72, 147456
    s_cselect_b32 s72, 0, s72
    s_waitcnt vmcnt(18)
    s_barrier
    s_add_u32 m0, s72, s74
    s_add_u32 s56, s71, 4096
    buffer_load_dwordx4 v26, s[16:19], s71 offen offset:0 sc1 lds
    buffer_load_dwordx4 v26, s[16:19], s71 offen offset:1024 sc1 lds
    buffer_load_dwordx4 v26, s[16:19], s71 offen offset:2048 sc1 lds
    buffer_load_dwordx4 v26, s[16:19], s71 offen offset:3072 sc1 lds
    s_add_u32 m0, m0, 4096
    s_add_u32 s71, s71, 20480
    buffer_load_dwordx4 v26, s[16:19], s56 offen sc1 lds
    s_add_u32 m0, s72, s73
    s_nop 0
    buffer_load_dwordx4 v26, s[16:19], s70 offen offset:0 sc1 lds
    buffer_load_dwordx4 v26, s[16:19], s70 offen offset:1024 sc1 lds
    buffer_load_dwordx4 v26, s[16:19], s70 offen offset:2048 sc1 lds
    buffer_load_dwordx4 v26, s[16:19], s70 offen offset:3072 sc1 lds
    s_add_u32 s70, s70, 4096
    s_add_u32 s72, s72, 36864
    s_cmp_eq_u32 s72, 147456
    s_cselect_b32 s72, 0, s72
    s_waitcnt vmcnt(23)
    s_barrier
    s_add_u32 m0, s72, s74
    s_add_u32 s56, s71, 4096
    buffer_load_dwordx4 v26, s[16:19], s71 offen offset:0 sc1 lds
    buffer_load_dwordx4 v26, s[16:19], s71 offen offset:1024 sc1 lds
    buffer_load_dwordx4 v26, s[16:19], s71 offen offset:2048 sc1 lds
    buffer_load_dwordx4 v26, s[16:19], s71 offen offset:3072 sc1 lds
    s_add_u32 m0, m0, 4096
    s_add_u32 s71, s71, 20480
    buffer_load_dwordx4 v26, s[16:19], s56 offen sc1 lds
    s_add_u32 m0, s72, s73
    s_nop 0
    buffer_load_dwordx4 v26, s[16:19], s70 offen offset:0 sc1 lds
    buffer_load_dwordx4 v26, s[16:19], s70 offen offset:1024 sc1 lds
    buffer_load_dwordx4 v26, s[16:19], s70 offen offset:2048 sc1 lds
    buffer_load_dwordx4 v26, s[16:19], s70 offen offset:3072 sc1 lds
    s_add_u32 s70, s70, 4096
    s_add_u32 s72, s72, 36864
    s_cmp_eq_u32 s72, 147456
    s_cselect_b32 s72, 0, s72
    s_waitcnt vmcnt(18)
    v_lshlrev_b32 v20, 16, v36
    v_and_b32 v21, 0xffff0000, v36
    s_mov_b64 exec, s[54:55]
    ds_write_b64 v17, v[20:21]
    s_mov_b64 exec, -1
    s_waitcnt lgkmcnt(0)
    s_barrier
    s_add_u32 m0, s72, s74
    s_add_u32 s56, s71, 4096
    buffer_load_dwordx4 v26, s[16:19], s71 offen offset:0 sc1 lds
    buffer_load_dwordx4 v26, s[16:19], s71 offen offset:1024 sc1 lds
    buffer_load_dwordx4 v26, s[16:19], s71 offen offset:2048 sc1 lds
    buffer_load_dwordx4 v26, s[16:19], s71 offen offset:3072 sc1 lds
    s_add_u32 m0, m0, 4096
    s_add_u32 s71, s71, 20480
    buffer_load_dwordx4 v26, s[16:19], s56 offen sc1 lds
    s_add_u32 m0, s72, s73
    s_nop 0
    buffer_load_dwordx4 v26, s[16:19], s70 offen offset:0 sc1 lds
    buffer_load_dwordx4 v26, s[16:19], s70 offen offset:1024 sc1 lds
    buffer_load_dwordx4 v26, s[16:19], s70 offen offset:2048 sc1 lds
    buffer_load_dwordx4 v26, s[16:19], s70 offen offset:3072 sc1 lds
    s_add_u32 s70, s70, 4096
    s_add_u32 s72, s72, 36864
    s_cmp_eq_u32 s72, 147456
    s_cselect_b32 s72, 0, s72
    s_mov_b32 s48, 5
L_ldF_p2b:
    s_waitcnt vmcnt(18)
    s_barrier
    s_add_u32 m0, s72, s74
    s_add_u32 s56, s71, 4096
    buffer_load_dwordx4 v26, s[16:19], s71 offen offset:0 sc1 lds
    buffer_load_dwordx4 v26, s[16:19], s71 offen offset:1024 sc1 lds
    buffer_load_dwordx4 v26, s[16:19], s71 offen offset:2048 sc1 lds
    buffer_load_dwordx4 v26, s[16:19], s71 offen offset:3072 sc1 lds
    s_add_u32 m0, m0, 4096
    s_add_u32 s71, s71, 20480
    buffer_load_dwordx4 v26, s[16:19], s56 offen sc1 lds
    s_add_u32 m0, s72, s73
    s_nop 0
    buffer_load_dwordx4 v26, s[16:19], s70 offen offset:0 sc1 lds
    buffer_load_dwordx4 v26, s[16:19], s70 offen offset:1024 sc1 lds
    buffer_load_dwordx4 v26, s[16:19], s70 offen offset:2048 sc1 lds
    buffer_load_dwordx4 v26, s[16:19], s70 offen offset:3072 sc1 lds
    s_add_u32 s70, s70, 4096
    s_add_u32 s72, s72, 36864
    s_cmp_eq_u32 s72, 147456
    s_cselect_b32 s72, 0, s72
    s_add_u32 s48, s48, 1
    s_cmp_lt_u32 s48, 14
    s_cbranch_scc1 L_ldF_p2b
    s_waitcnt vmcnt(18)
    s_barrier
    s_waitcnt vmcnt(9)
    s_barrier
    s_waitcnt vmcnt(0)
    s_barrier
    s_mov_b64 exec, -1
    s_endpgm
L_compute:
    s_getpc_b64 s[56:57]
L_pc:
    s_sub_u32 s56, s56, L_pc-recurrent_scan__sliding_local_dilated__dense_activation_squared_relu__prompt_kernel
    s_subb_u32 s57, s57, 0
    v_lshlrev_b32 v17, 7, v0
    v_min_u32 v17, L_end-recurrent_scan__sliding_local_dilated__dense_activation_squared_relu__prompt_kernel, v17
    s_bfe_u32 s58, s2, 0x20004
    s_cmp_lg_u32 s58, 0
    s_cbranch_scc1 L_nopf
    s_cmp_gt_u32 s40, 4
    s_cbranch_scc1 L_nopf
    global_load_dword v0, v17, s[56:57]
L_nopf:
    v_and_b32 v17, 15, v1
    v_lshrrev_b32 v18, 1, v17
    v_xor_b32 v18, v18, v16
    v_lshlrev_b32 v18, 4, v18
    v_lshl_add_u32 v11, v17, 7, v18
    v_xor_b32 v12, 64, v11
    v_mov_b32 v14, v11
    v_bfe_u32 v17, v1, 2, 2
    v_and_b32 v18, 3, v1
    s_mov_b32 s48, 0
    s_lshl_b32 s56, s43, 4
    s_add_u32 s56, s56, s42
    s_and_b32 s57, s2, 8
    s_add_u32 s56, s56, s57
    s_lshl_b32 s56, s56, 3
    s_add_u32 s56, s56, s40
    s_lshl_b32 s99, s56, 4
    s_add_u32 s99, s99, 11698176
    s_mul_i32 s56, s56, 1280
    v_lshlrev_b32 v136, 4, v1
    v_lshlrev_b32 v137, 2, v1
    s_waitcnt lgkmcnt(0)
    s_mov_b32 s8, s4
    s_and_b32 s9, s5, 0xffff
    s_mov_b32 s10, 2621440
    s_mov_b32 s11, 0x00020000
    buffer_load_dwordx4 v[128:131], v136, s[8:11], s56 offen
    buffer_load_dword v132, v137, s[8:11], s56 offen offset:1024
    s_add_u32 s30, s68, 11796480
    s_addc_u32 s31, s69, 0
    s_load_dwordx2 s[30:31], s[30:31], 0
    s_mov_b32 s16, s68
    s_and_b32 s17, s69, 0xffff
    s_mov_b32 s18, 11796608
    s_mov_b32 s19, 0x00020000
    s_bitcmp1_b32 s2, 3
    s_cbranch_scc1 L_F
    v_mul_u32_u24 v10, 3968, v16
    v_mul_u32_u24 v19, 480, v17
    v_add_u32 v10, v10, v19
    v_mul_u32_u24 v19, 40, v18
    v_add_u32 v10, v10, v19
    v_mov_b32 v13, v10
    v_and_b32 v19, 31, v1
    v_lshlrev_b32 v19, 2, v19
    v_mov_b32 v20, 0x3f803f80
    ds_write_b32 v19, v20 offset:31744
    v_add_u32 v19, 50176, v19
    ds_write_b32 v19, v20 offset:31744
    v_add_u32 v19, 50176, v19
    ds_write_b32 v19, v20 offset:31744
    v_mov_b32 v32, 0
    v_mov_b32 v33, 0
    v_mov_b32 v34, 0
    v_mov_b32 v35, 0
    v_mov_b32 v36, 0
    v_mov_b32 v37, 0
    v_mov_b32 v38, 0
    v_mov_b32 v39, 0
    v_mov_b32 v40, 0
    v_mov_b32 v41, 0
    v_mov_b32 v42, 0
    v_mov_b32 v43, 0
    v_mov_b32 v44, 0
    v_mov_b32 v45, 0
    v_mov_b32 v46, 0
    v_mov_b32 v47, 0
    v_mov_b32 v48, 0
    v_mov_b32 v49, 0
    v_mov_b32 v50, 0
    v_mov_b32 v51, 0
    v_mov_b32 v52, 0
    v_mov_b32 v53, 0
    v_mov_b32 v54, 0
    v_mov_b32 v55, 0
    v_mov_b32 v56, 0
    v_mov_b32 v57, 0
    v_mov_b32 v58, 0
    v_mov_b32 v59, 0
    v_mov_b32 v60, 0
    v_mov_b32 v61, 0
    v_mov_b32 v62, 0
    v_mov_b32 v63, 0
    v_mov_b32 v64, 0
    v_mov_b32 v65, 0
    v_mov_b32 v66, 0
    v_mov_b32 v67, 0
    v_mov_b32 v68, 0
    v_mov_b32 v69, 0
    v_mov_b32 v70, 0
    v_mov_b32 v71, 0
    v_mov_b32 v72, 0
    v_mov_b32 v73, 0
    v_mov_b32 v74, 0
    v_mov_b32 v75, 0
    v_mov_b32 v76, 0
    v_mov_b32 v77, 0
    v_mov_b32 v78, 0
    v_mov_b32 v79, 0
    v_mov_b32 v80, 0
    v_mov_b32 v81, 0
    v_mov_b32 v82, 0
    v_mov_b32 v83, 0
    v_mov_b32 v84, 0
    v_mov_b32 v85, 0
    v_mov_b32 v86, 0
    v_mov_b32 v87, 0
    v_mov_b32 v88, 0
    v_mov_b32 v89, 0
    v_mov_b32 v90, 0
    v_mov_b32 v91, 0
    v_mov_b32 v92, 0
    v_mov_b32 v93, 0
    v_mov_b32 v94, 0
    v_mov_b32 v95, 0
    v_mov_b32 v96, 0
    v_mov_b32 v97, 0
    v_mov_b32 v98, 0
    v_mov_b32 v99, 0
    v_mov_b32 v100, 0
    v_mov_b32 v101, 0
    v_mov_b32 v102, 0
    v_mov_b32 v103, 0
    v_mov_b32 v104, 0
    v_mov_b32 v105, 0
    v_mov_b32 v106, 0
    v_mov_b32 v107, 0
    v_mov_b32 v108, 0
    v_mov_b32 v109, 0
    v_mov_b32 v110, 0
    v_mov_b32 v111, 0
    s_mov_b32 s45, 50176
    s_lshl_b32 s56, s40, 2
    s_lshr_b32 s70, 0x11101000, s56
    s_and_b32 s70, s70, 15
    s_lshr_b32 s71, 0x80cc4840, s56
    s_and_b32 s71, s71, 15
    s_lshr_b32 s72, 0xa0ec4840, s56
    s_and_b32 s72, s72, 15
    s_lshr_b32 s73, 0x20120244, s56
    s_and_b32 s73, s73, 15
    s_lshr_b32 s74, 0x44334444, s56
    s_and_b32 s74, s74, 15
    v_mov_b32 v112, v16
    v_mov_b32 v114, v17
    v_mov_b32 v115, v18
    v_and_b32 v113, 15, v1
    v_lshlrev_b32 v116, 4, v112
    s_lshl_b32 s56, s72, 6
    s_add_u32 s56, s56, 151680
    v_add_u32 v16, s56, v116
    s_lshl_b32 s56, s71, 6
    s_add_u32 s56, s56, 151680
    v_add_u32 v15, s56, v116
    v_lshlrev_b32 v17, 3, v113
    v_add_u32 v17, 150528, v17
    s_lshl_b32 s56, s70, 9
    v_add_u32 v18, s56, v17
    v_mul_u32_u24 v116, 640, v112
    v_lshl_add_u32 v116, v113, 3, v116
    v_lshrrev_b32 v9, 3, v113
    v_mul_u32_u24 v9, 2496, v9
    s_mul_i32 s56, s72, 5120
    s_add_u32 s56, s56, 73728
    v_add3_u32 v9, v9, v116, s56
    s_and_b32 s56, s40, 1
    s_mul_i32 s58, s56, 320
    s_mul_i32 s56, s56, 2560
    s_lshr_b32 s57, s40, 1
    s_lshl_b32 s59, s57, 6
    s_add_u32 s58, s58, s59
    s_add_u32 s58, s58, 152640
    s_lshl_b32 s57, s57, 7
    s_add_u32 s56, s56, s57
    s_add_u32 s56, s56, 73728
    v_add_u32 v2, s56, v116
    v_add_u32 v3, 51264, v2
    v_lshl_add_u32 v117, v115, 2, v114
    v_mul_u32_u24 v4, 640, v112
    v_lshl_add_u32 v4, v117, 3, v4
    v_add_u32 v4, s56, v4
    v_lshlrev_b32 v5, 4, v114
    v_add_u32 v5, s58, v5
    v_lshl_add_u32 v19, v115, 2, v5
    s_mul_i32 s56, s71, 5120
    s_lshl_b32 s57, s70, 8
    s_add_u32 s56, s56, s57
    s_add_u32 s56, s56, 73792
    v_add_u32 v8, s56, v116
    v_lshlrev_b32 v6, 4, v1
    v_lshrrev_b32 v7, 5, v1
    v_lshlrev_b32 v7, 8, v7
    v_lshl_add_u32 v7, v113, 4, v7
    v_bfe_u32 v117, v1, 4, 1
    v_lshl_add_u32 v7, v117, 3, v7
    v_lshlrev_b32 v116, 2, v114
    s_lshr_b32 s56, s40, 1
    s_or_b32 s56, s43, s56
    s_cmp_eq_u32 s56, 0
    s_cselect_b32 s56, 8, 0
    v_sub_u32 v116, s56, v116
    v_add_u32 v117, 1, v115
    v_max_i32 v116, v116, v117
    v_cvt_f32_i32 v116, v116
    v_cvt_f32_i32 v117, v115
    v_mov_b32 v112, 0xf1800000
    v_mov_b32 v113, 0x71800000
    v_fmaak_f32 v20, v116, v112, 0x71800000
    v_min_f32 v20, 0, v20
    v_fmaak_f32 v21, v116, v112, 0x72000000
    v_min_f32 v21, 0, v21
    v_fmaak_f32 v22, v116, v112, 0x72400000
    v_min_f32 v22, 0, v22
    v_fmaak_f32 v23, v116, v112, 0x72800000
    v_min_f32 v23, 0, v23
    v_fmaak_f32 v24, v116, v112, 0x72a00000
    v_min_f32 v24, 0, v24
    v_fmaak_f32 v25, v116, v112, 0x72c00000
    v_min_f32 v25, 0, v25
    v_fmaak_f32 v26, v116, v112, 0x72e00000
    v_min_f32 v26, 0, v26
    v_fmaak_f32 v27, v117, v113, 0xf1800000
    v_min_f32 v27, 0, v27
    v_fmaak_f32 v28, v117, v113, 0xf2000000
    v_min_f32 v28, 0, v28
    v_fmaak_f32 v29, v117, v113, 0xf2400000
    v_min_f32 v29, 0, v29
    s_lshl_b32 s56, s43, 3
    s_add_u32 s56, s56, s40
    s_mul_i32 s56, s56, 68
    s_lshr_b32 s57, s42, 1
    s_mul_i32 s57, s57, 5
    s_add_u32 s56, s56, s57
    s_add_u32 s56, s56, 48
    s_and_b32 s57, s42, 1
    s_lshl_b32 s75, s57, 1
    s_add_u32 s75, s75, s56
    s_lshl_b32 s75, s75, 10
    s_add_u32 s56, s56, 4
    s_lshl_b32 s56, s56, 10
    s_lshl_b32 s57, s57, 9
    s_add_u32 s76, s56, s57
    s_mov_b32 s52, 0x00010001
    s_mov_b32 s53, 0x00010001
    s_waitcnt lgkmcnt(0)
    s_add_u32 s30, s30, 1
    s_addc_u32 s31, s31, 0
    s_waitcnt vmcnt(0)
    v_lshlrev_b32 v140, 16, v128
    v_and_b32 v141, 0xffff0000, v128
    v_lshlrev_b32 v142, 16, v129
    v_and_b32 v143, 0xffff0000, v129
    v_lshlrev_b32 v144, 16, v130
    v_and_b32 v145, 0xffff0000, v130
    v_lshlrev_b32 v146, 16, v131
    v_and_b32 v147, 0xffff0000, v131
    v_lshlrev_b32 v148, 16, v132
    v_and_b32 v149, 0xffff0000, v132
    v_add_f32 v152, v140, v141
    v_add_f32 v153, v142, v143
    v_add_f32 v152, v152, v144
    v_add_f32 v153, v153, v145
    v_add_f32 v152, v152, v146
    v_add_f32 v153, v153, v147
    v_add_f32 v152, v152, v148
    v_add_f32 v153, v153, v149
    v_add_f32 v152, v152, v153
    s_nop 1
    v_add_f32_dpp v152, v152, v152 quad_perm:[1,0,3,2] row_mask:0xf bank_mask:0xf
    s_nop 1
    v_add_f32_dpp v152, v152, v152 quad_perm:[2,3,0,1] row_mask:0xf bank_mask:0xf
    s_nop 1
    v_add_f32_dpp v152, v152, v152 row_half_mirror row_mask:0xf bank_mask:0xf
    s_nop 1
    v_add_f32_dpp v152, v152, v152 row_mirror row_mask:0xf bank_mask:0xf
    v_mov_b32 v153, v152
    s_nop 1
    v_permlane16_swap_b32 v152, v153
    s_nop 0
    v_add_f32 v152, v152, v153
    v_mov_b32 v153, v152
    s_nop 1
    v_permlane32_swap_b32 v152, v153
    s_nop 0
    v_add_f32 v152, v152, v153
    v_mul_f32 v156, 0xbacccccd, v152
    v_add_f32 v140, v140, v156
    v_add_f32 v141, v141, v156
    v_add_f32 v142, v142, v156
    v_add_f32 v143, v143, v156
    v_add_f32 v144, v144, v156
    v_add_f32 v145, v145, v156
    v_add_f32 v146, v146, v156
    v_add_f32 v147, v147, v156
    v_add_f32 v148, v148, v156
    v_add_f32 v149, v149, v156
    v_mul_f32 v152, v140, v140
    v_mul_f32 v153, v141, v141
    v_fmac_f32 v152, v142, v142
    v_fmac_f32 v153, v143, v143
    v_fmac_f32 v152, v144, v144
    v_fmac_f32 v153, v145, v145
    v_fmac_f32 v152, v146, v146
    v_fmac_f32 v153, v147, v147
    v_fmac_f32 v152, v148, v148
    v_fmac_f32 v153, v149, v149
    v_add_f32 v152, v152, v153
    s_nop 1
    v_add_f32_dpp v152, v152, v152 quad_perm:[1,0,3,2] row_mask:0xf bank_mask:0xf
    s_nop 1
    v_add_f32_dpp v152, v152, v152 quad_perm:[2,3,0,1] row_mask:0xf bank_mask:0xf
    s_nop 1
    v_add_f32_dpp v152, v152, v152 row_half_mirror row_mask:0xf bank_mask:0xf
    s_nop 1
    v_add_f32_dpp v152, v152, v152 row_mirror row_mask:0xf bank_mask:0xf
    v_mov_b32 v153, v152
    s_nop 1
    v_permlane16_swap_b32 v152, v153
    s_nop 0
    v_add_f32 v152, v152, v153
    v_mov_b32 v153, v152
    s_nop 1
    v_permlane32_swap_b32 v152, v153
    s_nop 0
    v_add_f32 v152, v152, v153
    v_mov_b32 v153, 0x3727c5ac
    v_fmac_f32 v153, 0x3acccccd, v152
    v_rsq_f32 v157, v153
    v_mov_b32 v158, s30
    v_mov_b32 v159, s31
    v_mov_b32 v152, 0
    s_mov_b64 exec, 1
    buffer_store_dwordx4 v[156:159], v152, s[16:19], s99 offen offset:0 sc1
    s_mov_b64 exec, -1
    s_cmp_ge_u32 s40, 3
    s_cbranch_scc1 L_notouchQ
    v_lshlrev_b32 v138, 7, v1
    s_mov_b32 s20, s6
    s_and_b32 s21, s7, 0xffff
    s_mov_b32 s22, 2457600
    s_mov_b32 s23, 0x00020000
    s_lshl_b32 s56, s43, 3
    s_add_u32 s56, s56, s42
    s_cmp_lt_u32 s56, 38
    s_cbranch_scc1 L_notouchQ
    s_mul_i32 s56, s56, 19200
    s_mul_i32 s57, s40, 6400
    s_add_u32 s56, s56, s57
    s_mov_b32 s58, -1
    s_mov_b32 s59, 0x3ffff
    s_mov_b64 exec, s[58:59]
    buffer_load_dword v0, v138, s[20:23], s56 offen
    s_mov_b64 exec, -1
L_notouchQ:
    s_cmp_eq_u32 s40, 0
    s_cbranch_scc1 L_p1_Q0
    s_cmp_eq_u32 s40, 1
    s_cbranch_scc1 L_p1_Q1
    s_cmp_eq_u32 s40, 2
    s_cbranch_scc1 L_p1_Q2
    s_cmp_eq_u32 s40, 3
    s_cbranch_scc1 L_p1_Q3
    s_cmp_eq_u32 s40, 4
    s_cbranch_scc1 L_p1_Q4
    s_cmp_eq_u32 s40, 5
    s_cbranch_scc1 L_p1_Q5
    s_cmp_eq_u32 s40, 6
    s_cbranch_scc1 L_p1_Q6
    s_branch L_p1_Q7
L_F:
    v_mul_u32_u24 v10, 3456, v16
    v_mul_u32_u24 v19, 416, v17
    v_add_u32 v10, v10, v19
    v_lshl_add_u32 v10, v18, 3, v10
    v_mov_b32 v13, v10
    s_mov_b32 s8, s4
    s_and_b32 s9, s5, 0xffff
    s_mov_b32 s10, 2621440
    s_mov_b32 s11, 0x00020000
    v_lshlrev_b32 v2, 4, v1
    s_lshl_b32 s56, s40, 2
    s_lshr_b32 s70, 0x11001100, s56
    s_and_b32 s70, s70, 15
    s_lshr_b32 s71, 0xa4a46060, s56
    s_and_b32 s71, s71, 15
    s_lshr_b32 s72, 0xb5a48260, s56
    s_and_b32 s72, s72, 15
    s_lshr_b32 s73, 0x11112222, s56
    s_and_b32 s73, s73, 15
    s_lshr_b32 s74, 0x22224444, s56
    s_and_b32 s74, s74, 15
    v_lshlrev_b32 v19, 4, v16
    s_lshl_b32 s56, s72, 6
    s_add_u32 s56, s56, 159744
    v_add_u32 v5, s56, v19
    s_lshl_b32 s56, s71, 6
    s_add_u32 s56, s56, 159744
    v_add_u32 v4, s56, v19
    v_and_b32 v6, 15, v1
    v_lshlrev_b32 v6, 3, v6
    s_lshl_b32 s56, s70, 9
    s_add_u32 s56, s56, 158720
    v_add_u32 v6, s56, v6
    s_mov_b32 s52, 0x00010001
    s_mov_b32 s53, 0x00010001
    s_lshl_b32 s46, s43, 7
    s_bfe_u32 s56, s2, 0x10004
    s_lshl_b32 s56, s56, 6
    s_add_u32 s46, s46, s56
    s_lshr_b32 s47, s2, 4
    s_cmp_ge_u32 s40, 4
    s_cbranch_scc1 L_F_helper
    v_mov_b32 v64, 0
    v_mov_b32 v65, 0
    v_mov_b32 v66, 0
    v_mov_b32 v67, 0
    v_mov_b32 v68, 0
    v_mov_b32 v69, 0
    v_mov_b32 v70, 0
    v_mov_b32 v71, 0
    v_mov_b32 v72, 0
    v_mov_b32 v73, 0
    v_mov_b32 v74, 0
    v_mov_b32 v75, 0
    v_mov_b32 v76, 0
    v_mov_b32 v77, 0
    v_mov_b32 v78, 0
    v_mov_b32 v79, 0
    v_mov_b32 v80, 0
    v_mov_b32 v81, 0
    v_mov_b32 v82, 0
    v_mov_b32 v83, 0
    v_mov_b32 v84, 0
    v_mov_b32 v85, 0
    v_mov_b32 v86, 0
    v_mov_b32 v87, 0
    v_mov_b32 v88, 0
    v_mov_b32 v89, 0
    v_mov_b32 v90, 0
    v_mov_b32 v91, 0
    v_mov_b32 v92, 0
    v_mov_b32 v93, 0
    v_mov_b32 v94, 0
    v_mov_b32 v95, 0
L_F_go:
    v_mov_b32 v32, 0
    v_mov_b32 v33, 0
    v_mov_b32 v34, 0
    v_mov_b32 v35, 0
    v_mov_b32 v36, 0
    v_mov_b32 v37, 0
    v_mov_b32 v38, 0
    v_mov_b32 v39, 0
    v_mov_b32 v40, 0
    v_mov_b32 v41, 0
    v_mov_b32 v42, 0
    v_mov_b32 v43, 0
    v_mov_b32 v44, 0
    v_mov_b32 v45, 0
    v_mov_b32 v46, 0
    v_mov_b32 v47, 0
    v_mov_b32 v48, 0
    v_mov_b32 v49, 0
    v_mov_b32 v50, 0
    v_mov_b32 v51, 0
    v_mov_b32 v52, 0
    v_mov_b32 v53, 0
    v_mov_b32 v54, 0
    v_mov_b32 v55, 0
    v_mov_b32 v56, 0
    v_mov_b32 v57, 0
    v_mov_b32 v58, 0
    v_mov_b32 v59, 0
    v_mov_b32 v60, 0
    v_mov_b32 v61, 0
    v_mov_b32 v62, 0
    v_mov_b32 v63, 0
    v_mov_b32 v96, 0
    v_mov_b32 v97, 0
    v_mov_b32 v98, 0
    v_mov_b32 v99, 0
    v_mov_b32 v100, 0
    v_mov_b32 v101, 0
    v_mov_b32 v102, 0
    v_mov_b32 v103, 0
    v_mov_b32 v28, 0x3f803f80
    v_mov_b32 v29, 0x3f803f80
    v_mov_b32 v30, 0x3f803f80
    v_mov_b32 v31, 0x3f803f80
    s_mov_b32 s45, 44032
    s_waitcnt lgkmcnt(0)
    s_add_u32 s30, s30, 1
    s_addc_u32 s31, s31, 0
    s_waitcnt vmcnt(0)
    v_lshlrev_b32 v140, 16, v128
    v_and_b32 v141, 0xffff0000, v128
    v_lshlrev_b32 v142, 16, v129
    v_and_b32 v143, 0xffff0000, v129
    v_lshlrev_b32 v144, 16, v130
    v_and_b32 v145, 0xffff0000, v130
    v_lshlrev_b32 v146, 16, v131
    v_and_b32 v147, 0xffff0000, v131
    v_lshlrev_b32 v148, 16, v132
    v_and_b32 v149, 0xffff0000, v132
    v_add_f32 v152, v140, v141
    v_add_f32 v153, v142, v143
    v_add_f32 v152, v152, v144
    v_add_f32 v153, v153, v145
    v_add_f32 v152, v152, v146
    v_add_f32 v153, v153, v147
    v_add_f32 v152, v152, v148
    v_add_f32 v153, v153, v149
    v_add_f32 v152, v152, v153
    s_nop 1
    v_add_f32_dpp v152, v152, v152 quad_perm:[1,0,3,2] row_mask:0xf bank_mask:0xf
    s_nop 1
    v_add_f32_dpp v152, v152, v152 quad_perm:[2,3,0,1] row_mask:0xf bank_mask:0xf
    s_nop 1
    v_add_f32_dpp v152, v152, v152 row_half_mirror row_mask:0xf bank_mask:0xf
    s_nop 1
    v_add_f32_dpp v152, v152, v152 row_mirror row_mask:0xf bank_mask:0xf
    v_mov_b32 v153, v152
    s_nop 1
    v_permlane16_swap_b32 v152, v153
    s_nop 0
    v_add_f32 v152, v152, v153
    v_mov_b32 v153, v152
    s_nop 1
    v_permlane32_swap_b32 v152, v153
    s_nop 0
    v_add_f32 v152, v152, v153
    v_mul_f32 v156, 0xbacccccd, v152
    v_add_f32 v140, v140, v156
    v_add_f32 v141, v141, v156
    v_add_f32 v142, v142, v156
    v_add_f32 v143, v143, v156
    v_add_f32 v144, v144, v156
    v_add_f32 v145, v145, v156
    v_add_f32 v146, v146, v156
    v_add_f32 v147, v147, v156
    v_add_f32 v148, v148, v156
    v_add_f32 v149, v149, v156
    v_mul_f32 v152, v140, v140
    v_mul_f32 v153, v141, v141
    v_fmac_f32 v152, v142, v142
    v_fmac_f32 v153, v143, v143
    v_fmac_f32 v152, v144, v144
    v_fmac_f32 v153, v145, v145
    v_fmac_f32 v152, v146, v146
    v_fmac_f32 v153, v147, v147
    v_fmac_f32 v152, v148, v148
    v_fmac_f32 v153, v149, v149
    v_add_f32 v152, v152, v153
    s_nop 1
    v_add_f32_dpp v152, v152, v152 quad_perm:[1,0,3,2] row_mask:0xf bank_mask:0xf
    s_nop 1
    v_add_f32_dpp v152, v152, v152 quad_perm:[2,3,0,1] row_mask:0xf bank_mask:0xf
    s_nop 1
    v_add_f32_dpp v152, v152, v152 row_half_mirror row_mask:0xf bank_mask:0xf
    s_nop 1
    v_add_f32_dpp v152, v152, v152 row_mirror row_mask:0xf bank_mask:0xf
    v_mov_b32 v153, v152
    s_nop 1
    v_permlane16_swap_b32 v152, v153
    s_nop 0
    v_add_f32 v152, v152, v153
    v_mov_b32 v153, v152
    s_nop 1
    v_permlane32_swap_b32 v152, v153
    s_nop 0
    v_add_f32 v152, v152, v153
    v_mov_b32 v153, 0x3727c5ac
    v_fmac_f32 v153, 0x3acccccd, v152
    v_rsq_f32 v157, v153
    v_mov_b32 v158, s30
    v_mov_b32 v159, s31
    v_mov_b32 v152, 0
    s_mov_b64 exec, 1
    buffer_store_dwordx4 v[156:159], v152, s[16:19], s99 offen offset:0 sc1
    s_mov_b64 exec, -1
    s_cmp_ge_u32 s40, 2
    s_cbranch_scc1 L_notouchF
    v_lshlrev_b32 v138, 7, v1
    s_mov_b32 s20, s32
    s_and_b32 s21, s33, 0xffff
    s_mov_b32 s22, 1966080
    s_mov_b32 s23, 0x00020000
    s_lshl_b32 s56, s43, 3
    s_add_u32 s56, s56, s42
    s_cmp_lt_u32 s56, 38
    s_cbranch_scc1 L_notouchF
    s_mul_i32 s56, s56, 15360
    s_mul_i32 s57, s40, 7680
    s_add_u32 s56, s56, s57
    s_mov_b32 s58, -1
    s_mov_b32 s59, 0xfffffff
    s_mov_b64 exec, s[58:59]
    buffer_load_dword v0, v138, s[20:23], s56 offen
    s_mov_b64 exec, -1
L_notouchF:
    s_cmp_eq_u32 s40, 0
    s_cbranch_scc1 L_p1_F0
    s_cmp_eq_u32 s40, 1
    s_cbranch_scc1 L_p1_F1
    s_cmp_eq_u32 s40, 2
    s_cbranch_scc1 L_p1_F2
    s_cmp_eq_u32 s40, 3
    s_cbranch_scc1 L_p1_F3
    s_cmp_eq_u32 s40, 4
    s_cbranch_scc1 L_p1_F4
    s_cmp_eq_u32 s40, 5
    s_cbranch_scc1 L_p1_F5
    s_cmp_eq_u32 s40, 6
    s_cbranch_scc1 L_p1_F6
    s_branch L_p1_F7
L_F_helper:
    v_mov_b32 v64, 0
    v_mov_b32 v65, 0
    v_mov_b32 v66, 0
    v_mov_b32 v67, 0
    v_mov_b32 v68, 0
    s_mov_b32 s12, s36
    s_and_b32 s13, s37, 0xffff
    s_mov_b32 s14, 1966080
    s_mov_b32 s15, 0x00020000
    s_mov_b32 s24, s34
    s_and_b32 s25, s35, 0xffff
    s_mov_b32 s26, 3072
    s_mov_b32 s27, 0x00020000
    s_bfe_u32 s49, s2, 0x20001
    s_mul_i32 s49, s49, 17
    s_add_u32 s49, s49, s47
    s_and_b32 s50, s2, 1
    s_lshl_b32 s50, s50, 2
    s_add_u32 s50, s50, s41
    s_mul_i32 s78, s41, 5120
    s_add_u32 s78, s78, 132096
    s_cmp_eq_u32 s47, s41
    s_cselect_b32 s79, 2, 1
    s_mov_b32 s62, 0
    v_lshrrev_b32 v3, 2, v1
    v_mul_u32_u24 v3, 160, v3
    v_mul_u32_u24 v20, 40, v18
    v_add_u32 v3, v3, v20
L_F_jobissue:
    s_sub_u32 s56, s49, 48
    s_mul_i32 s44, s56, 52
    s_lshr_b32 s44, s44, 8
    s_mul_i32 s98, s44, 5
    s_sub_u32 s98, s56, s98
    s_mul_i32 s44, s44, 160
    s_lshr_b32 s51, s98, 1
    s_mul_i32 s51, s51, 80
    s_and_b32 s54, s98, 1
    s_lshl_b32 s54, s54, 3
    s_add_u32 s51, s51, s54
    s_cmp_eq_u32 s98, 4
    s_cselect_b32 s51, 16, s51
    s_cselect_b32 s54, 40, 20
    s_cselect_b32 s55, 20, 4
    s_add_u32 s51, s51, s44
    s_lshl_b32 s44, s49, 5
    s_mov_b32 s22, 819200
    s_cmp_ge_u32 s49, 48
    s_cselect_b32 s51, s51, s44
    s_cselect_b32 s54, s54, 4
    s_cselect_b32 s55, s55, 16
    s_cselect_b32 s20, s28, s36
    s_cselect_b32 s21, s29, s37
    s_cselect_b32 s22, s22, 1966080
    s_and_b32 s21, s21, 0xffff
    s_mov_b32 s23, 0x00020000
    s_mul_i32 s51, s51, 1280
    s_mul_i32 s44, s50, 160
    s_add_u32 s51, s51, s44
    s_mul_i32 s54, s54, 1280
    s_mul_i32 s55, s55, 1280
    s_mul_i32 s77, s50, 68
    s_add_u32 s77, s77, s49
    s_mul_i32 s77, s77, 5120
    s_add_u32 s77, s77, 8912896
    v_add_u32 v19, 0, v1
    v_mul_u32_u24 v20, 205, v19
    v_lshrrev_b32 v20, 11, v20
    v_mul_u32_u24 v21, 10, v20
    v_sub_u32 v19, v19, v21
    v_and_b32 v21, 3, v20
    v_mul_u32_u24 v21, 1280, v21
    v_lshl_add_u32 v19, v19, 4, v21
    v_bfe_u32 v21, v20, 2, 2
    v_mad_u32_u24 v19, v21, s54, v19
    v_lshrrev_b32 v21, 4, v20
    v_mad_u32_u24 v19, v21, s55, v19
    v_add_u32 v72, s51, v19
    v_add_u32 v19, 64, v1
    v_mul_u32_u24 v20, 205, v19
    v_lshrrev_b32 v20, 11, v20
    v_mul_u32_u24 v21, 10, v20
    v_sub_u32 v19, v19, v21
    v_and_b32 v21, 3, v20
    v_mul_u32_u24 v21, 1280, v21
    v_lshl_add_u32 v19, v19, 4, v21
    v_bfe_u32 v21, v20, 2, 2
    v_mad_u32_u24 v19, v21, s54, v19
    v_lshrrev_b32 v21, 4, v20
    v_mad_u32_u24 v19, v21, s55, v19
    v_add_u32 v73, s51, v19
    v_add_u32 v19, 128, v1
    v_mul_u32_u24 v20, 205, v19
    v_lshrrev_b32 v20, 11, v20
    v_mul_u32_u24 v21, 10, v20
    v_sub_u32 v19, v19, v21
    v_and_b32 v21, 3, v20
    v_mul_u32_u24 v21, 1280, v21
    v_lshl_add_u32 v19, v19, 4, v21
    v_bfe_u32 v21, v20, 2, 2
    v_mad_u32_u24 v19, v21, s54, v19
    v_lshrrev_b32 v21, 4, v20
    v_mad_u32_u24 v19, v21, s55, v19
    v_add_u32 v74, s51, v19
    v_add_u32 v19, 192, v1
    v_mul_u32_u24 v20, 205, v19
    v_lshrrev_b32 v20, 11, v20
    v_mul_u32_u24 v21, 10, v20
    v_sub_u32 v19, v19, v21
    v_and_b32 v21, 3, v20
    v_mul_u32_u24 v21, 1280, v21
    v_lshl_add_u32 v19, v19, 4, v21
    v_bfe_u32 v21, v20, 2, 2
    v_mad_u32_u24 v19, v21, s54, v19
    v_lshrrev_b32 v21, 4, v20
    v_mad_u32_u24 v19, v21, s55, v19
    v_add_u32 v75, s51, v19
    v_add_u32 v19, 256, v1
    v_mul_u32_u24 v20, 205, v19
    v_lshrrev_b32 v20, 11, v20
    v_mul_u32_u24 v21, 10, v20
    v_sub_u32 v19, v19, v21
    v_and_b32 v21, 3, v20
    v_mul_u32_u24 v21, 1280, v21
    v_lshl_add_u32 v19, v19, 4, v21
    v_bfe_u32 v21, v20, 2, 2
    v_mad_u32_u24 v19, v21, s54, v19
    v_lshrrev_b32 v21, 4, v20
    v_mad_u32_u24 v19, v21, s55, v19
    v_add_u32 v76, s51, v19
    s_add_u32 s62, s62, 1
    s_cmp_ge_u32 s62, 2
    s_cbranch_scc1 L_F_jobs_done
    s_mov_b32 s76, s77
    v_mov_b32 v64, v72
    v_mov_b32 v65, v73
    v_mov_b32 v66, v74
    v_mov_b32 v67, v75
    v_mov_b32 v68, v76
    s_mov_b32 s12, s20
    s_mov_b32 s13, s21
    s_mov_b32 s14, s22
    s_mov_b32 s15, 0x00020000
    s_cmp_eq_u32 s79, 1
    s_cbranch_scc1 L_F_jobs_done
    s_sub_u32 s49, s49, s47
    s_add_u32 s49, s49, 16
    s_branch L_F_jobissue
L_F_jobs_done:
    s_setprio 1
    s_branch L_F_go
L_task_jdma:
    s_mul_i32 s60, s42, 384
    v_lshlrev_b32 v19, 3, v1
    buffer_load_dwordx2 v[70:71], v19, s[24:27], s60 offen
    s_mov_b32 m0, s78
    s_nop 0
    buffer_load_dwordx4 v64, s[12:15], 0 offen lds
    s_add_u32 m0, m0, 1024
    s_nop 0
    buffer_load_dwordx4 v65, s[12:15], 0 offen lds
    s_add_u32 m0, m0, 1024
    s_nop 0
    buffer_load_dwordx4 v66, s[12:15], 0 offen lds
    s_add_u32 m0, m0, 1024
    s_nop 0
    buffer_load_dwordx4 v67, s[12:15], 0 offen lds
    s_add_u32 m0, m0, 1024
    s_nop 0
    buffer_load_dwordx4 v68, s[12:15], 0 offen lds
    s_add_u32 m0, m0, 1024
    s_cmp_eq_u32 s79, 1
    s_cbranch_scc1 L_task_ret
    s_mov_b32 m0, 152576
    s_nop 0
    buffer_load_dwordx4 v72, s[20:23], 0 offen lds
    s_add_u32 m0, m0, 1024
    s_nop 0
    buffer_load_dwordx4 v73, s[20:23], 0 offen lds
    s_add_u32 m0, m0, 1024
    s_nop 0
    buffer_load_dwordx4 v74, s[20:23], 0 offen lds
    s_add_u32 m0, m0, 1024
    s_nop 0
    buffer_load_dwordx4 v75, s[20:23], 0 offen lds
    s_add_u32 m0, m0, 1024
    s_nop 0
    buffer_load_dwordx4 v76, s[20:23], 0 offen lds
    s_add_u32 m0, m0, 1024
    s_setpc_b64 s[96:97]
L_task:
    s_cmp_eq_u32 s48, 0
    s_cbranch_scc1 L_task_jdma
    s_cmp_eq_u32 s48, 2
    s_cbranch_scc1 L_task_0
    s_cmp_eq_u32 s48, 3
    s_cbranch_scc1 L_task_j2
    s_cmp_eq_u32 s48, 6
    s_cbranch_scc1 L_task_6
    s_cmp_lg_u32 s48, 5
    s_cbranch_scc1 L_task_ret
    s_waitcnt vmcnt(0)
    s_setpc_b64 s[96:97]
L_task_0:
    s_waitcnt vmcnt(0)
    v_lshlrev_b32 v16, 16, v70
    v_and_b32 v17, 0xffff0000, v70
    v_lshlrev_b32 v18, 16, v71
    v_and_b32 v19, 0xffff0000, v71
    v_add_u32 v20, 160512, v2
    s_mov_b32 s58, -1
    s_mov_b32 s59, 0xffff
    s_mov_b64 exec, s[58:59]
    ds_write_b128 v20, v[16:19]
    s_mov_b64 exec, -1
    v_add_u32 v24, s78, v3
    s_mov_b32 s56, s76
L_task_job:
    s_add_u32 s57, s56, 4096
    s_waitcnt lgkmcnt(0)
    ds_read_b64_tr_b16 v[76:77], v24 offset:0
    ds_read_b64_tr_b16 v[78:79], v24 offset:2560
    ds_read_b64_tr_b16 v[80:81], v24 offset:8
    ds_read_b64_tr_b16 v[82:83], v24 offset:2568
    ds_read_b64_tr_b16 v[84:85], v24 offset:16
    ds_read_b64_tr_b16 v[86:87], v24 offset:2576
    ds_read_b64_tr_b16 v[88:89], v24 offset:24
    ds_read_b64_tr_b16 v[90:91], v24 offset:2584
    ds_read_b64_tr_b16 v[92:93], v24 offset:32
    ds_read_b64_tr_b16 v[94:95], v24 offset:2592
    s_waitcnt lgkmcnt(8)
    buffer_store_dwordx4 v[76:79], v2, s[16:19], s56 offen offset:0 sc1
    s_waitcnt lgkmcnt(6)
    buffer_store_dwordx4 v[80:83], v2, s[16:19], s56 offen offset:1024 sc1
    s_waitcnt lgkmcnt(4)
    buffer_store_dwordx4 v[84:87], v2, s[16:19], s56 offen offset:2048 sc1
    s_waitcnt lgkmcnt(2)
    buffer_store_dwordx4 v[88:91], v2, s[16:19], s56 offen offset:3072 sc1
    s_waitcnt lgkmcnt(0)
    buffer_store_dwordx4 v[92:95], v2, s[16:19], s57 offen offset:0 sc1
    s_setpc_b64 s[96:97]
L_task_6:
    s_cmp_lg_u32 s40, 4
    s_cbranch_scc1 L_task_ret
    s_lshl_b32 s56, s43, 4
    s_add_u32 s56, s56, s42
    s_lshl_b32 s56, s56, 7
    s_add_u32 s56, s56, 11731968
    v_mov_b32 v24, s30
    v_mov_b32 v25, s31
    v_mov_b32 v26, 0
    s_mov_b64 exec, 1
    buffer_store_dwordx2 v[24:25], v26, s[16:19], s56 offen offset:8 sc1
    s_mov_b64 exec, -1
    s_setpc_b64 s[96:97]
L_task_j2:
    s_cmp_eq_u32 s79, 1
    s_cbranch_scc1 L_task_ret
    v_add_u32 v24, 152576, v3
    s_mov_b32 s56, s77
    s_branch L_task_job
L_task_ret:
    s_setpc_b64 s[96:97]
L_p1_Q0:
    s_barrier
    ds_read_b128 v[128:131], v14 offset:33792
    ds_read_b128 v[132:135], v14 offset:35840
    ds_read_b128 v[136:139], v14 offset:37888
    ds_read_b128 v[140:143], v14 offset:39936
    ds_read_b128 v[144:147], v14 offset:31744
    ds_read_b64_tr_b16 v[112:113], v13 offset:0
    ds_read_b64_tr_b16 v[114:115], v13 offset:1920
    ds_read_b64_tr_b16 v[116:117], v13 offset:8
    ds_read_b64_tr_b16 v[118:119], v13 offset:1928
    ds_read_b64_tr_b16 v[120:121], v13 offset:16
    ds_read_b64_tr_b16 v[122:123], v13 offset:1936
    ds_read_b64_tr_b16 v[124:125], v13 offset:24
    ds_read_b64_tr_b16 v[126:127], v13 offset:1944
    v_mov_b32 v14, v12
    s_waitcnt lgkmcnt(0)
L_p1_Q0_loop:
    s_waitcnt lgkmcnt(6)
    v_mfma_f32_16x16x32_bf16 v[32:35], v[112:115], v[128:131], v[32:35]
    ds_read_b128 v[148:151], v14 offset:33792
    v_mfma_f32_16x16x32_bf16 v[36:39], v[112:115], v[132:135], v[36:39]
    ds_read_b128 v[152:155], v14 offset:35840
    v_mfma_f32_16x16x32_bf16 v[40:43], v[112:115], v[136:139], v[40:43]
    ds_read_b128 v[156:159], v14 offset:37888
    v_mfma_f32_16x16x32_bf16 v[44:47], v[112:115], v[140:143], v[44:47]
    ds_read_b128 v[160:163], v14 offset:39936
    v_mfma_f32_16x16x32_bf16 v[96:99], v[112:115], v[144:147], v[96:99]
    ds_read_b128 v[164:167], v14 offset:31744
    s_waitcnt lgkmcnt(9)
    v_mfma_f32_16x16x32_bf16 v[48:51], v[116:119], v[128:131], v[48:51]
    ds_read_b64_tr_b16 v[112:113], v13 offset:15872
    v_mfma_f32_16x16x32_bf16 v[52:55], v[116:119], v[132:135], v[52:55]
    ds_read_b64_tr_b16 v[114:115], v13 offset:17792
    v_mfma_f32_16x16x32_bf16 v[56:59], v[116:119], v[136:139], v[56:59]
    v_mfma_f32_16x16x32_bf16 v[60:63], v[116:119], v[140:143], v[60:63]
    v_mfma_f32_16x16x32_bf16 v[100:103], v[116:119], v[144:147], v[100:103]
    ds_read_b64_tr_b16 v[116:117], v13 offset:15880
    s_waitcnt lgkmcnt(10)
    v_mfma_f32_16x16x32_bf16 v[64:67], v[120:123], v[128:131], v[64:67]
    ds_read_b64_tr_b16 v[118:119], v13 offset:17800
    v_mfma_f32_16x16x32_bf16 v[68:71], v[120:123], v[132:135], v[68:71]
    v_mfma_f32_16x16x32_bf16 v[72:75], v[120:123], v[136:139], v[72:75]
    v_mfma_f32_16x16x32_bf16 v[76:79], v[120:123], v[140:143], v[76:79]
    v_mfma_f32_16x16x32_bf16 v[104:107], v[120:123], v[144:147], v[104:107]
    ds_read_b64_tr_b16 v[120:121], v13 offset:15888
    s_waitcnt lgkmcnt(10)
    v_mfma_f32_16x16x32_bf16 v[80:83], v[124:127], v[128:131], v[80:83]
    ds_read_b64_tr_b16 v[122:123], v13 offset:17808
    v_mfma_f32_16x16x32_bf16 v[84:87], v[124:127], v[132:135], v[84:87]
    v_mfma_f32_16x16x32_bf16 v[88:91], v[124:127], v[136:139], v[88:91]
    v_mfma_f32_16x16x32_bf16 v[92:95], v[124:127], v[140:143], v[92:95]
    v_mfma_f32_16x16x32_bf16 v[108:111], v[124:127], v[144:147], v[108:111]
    ds_read_b64_tr_b16 v[124:125], v13 offset:15896
    ds_read_b64_tr_b16 v[126:127], v13 offset:17816
    s_waitcnt lgkmcnt(6)
    v_mfma_f32_16x16x32_bf16 v[32:35], v[112:115], v[148:151], v[32:35]
    v_mfma_f32_16x16x32_bf16 v[36:39], v[112:115], v[152:155], v[36:39]
    v_mfma_f32_16x16x32_bf16 v[40:43], v[112:115], v[156:159], v[40:43]
    v_mfma_f32_16x16x32_bf16 v[44:47], v[112:115], v[160:163], v[44:47]
    v_mfma_f32_16x16x32_bf16 v[96:99], v[112:115], v[164:167], v[96:99]
    v_add_u32 v14, s45, v11
    v_add_u32 v13, s45, v10
    s_waitcnt lgkmcnt(0)
    s_barrier
    v_mfma_f32_16x16x32_bf16 v[48:51], v[116:119], v[148:151], v[48:51]
    ds_read_b128 v[128:131], v14 offset:33792
    v_mfma_f32_16x16x32_bf16 v[52:55], v[116:119], v[152:155], v[52:55]
    ds_read_b128 v[132:135], v14 offset:35840
    v_mfma_f32_16x16x32_bf16 v[56:59], v[116:119], v[156:159], v[56:59]
    ds_read_b128 v[136:139], v14 offset:37888
    v_mfma_f32_16x16x32_bf16 v[60:63], v[116:119], v[160:163], v[60:63]
    ds_read_b128 v[140:143], v14 offset:39936
    v_mfma_f32_16x16x32_bf16 v[100:103], v[116:119], v[164:167], v[100:103]
    ds_read_b128 v[144:147], v14 offset:31744
    v_mfma_f32_16x16x32_bf16 v[64:67], v[120:123], v[148:151], v[64:67]
    ds_read_b64_tr_b16 v[112:113], v13 offset:0
    v_mfma_f32_16x16x32_bf16 v[68:71], v[120:123], v[152:155], v[68:71]
    ds_read_b64_tr_b16 v[114:115], v13 offset:1920
    v_mfma_f32_16x16x32_bf16 v[72:75], v[120:123], v[156:159], v[72:75]
    ds_read_b64_tr_b16 v[116:117], v13 offset:8
    v_mfma_f32_16x16x32_bf16 v[76:79], v[120:123], v[160:163], v[76:79]
    ds_read_b64_tr_b16 v[118:119], v13 offset:1928
    v_mfma_f32_16x16x32_bf16 v[104:107], v[120:123], v[164:167], v[104:107]
    ds_read_b64_tr_b16 v[120:121], v13 offset:16
    v_mfma_f32_16x16x32_bf16 v[80:83], v[124:127], v[148:151], v[80:83]
    ds_read_b64_tr_b16 v[122:123], v13 offset:1936
    v_mfma_f32_16x16x32_bf16 v[84:87], v[124:127], v[152:155], v[84:87]
    v_mfma_f32_16x16x32_bf16 v[88:91], v[124:127], v[156:159], v[88:91]
    v_mfma_f32_16x16x32_bf16 v[92:95], v[124:127], v[160:163], v[92:95]
    v_mfma_f32_16x16x32_bf16 v[108:111], v[124:127], v[164:167], v[108:111]
    ds_read_b64_tr_b16 v[124:125], v13 offset:24
    ds_read_b64_tr_b16 v[126:127], v13 offset:1944
    v_add_u32 v14, s45, v12
    s_add_u32 s45, s45, 50176
    s_cmp_eq_u32 s45, 150528
    s_cselect_b32 s45, 0, s45
    s_add_u32 s48, s48, 1
    s_cmp_lt_u32 s48, 10
    s_cbranch_scc1 L_p1_Q0_loop
    s_waitcnt lgkmcnt(0)
    s_branch L_epi_Q
L_p1_Q1:
    s_barrier
    ds_read_b128 v[128:131], v14 offset:33792
    ds_read_b128 v[132:135], v14 offset:35840
    ds_read_b128 v[136:139], v14 offset:37888
    ds_read_b128 v[140:143], v14 offset:39936
    ds_read_b128 v[144:147], v14 offset:31744
    ds_read_b64_tr_b16 v[112:113], v13 offset:32
    ds_read_b64_tr_b16 v[114:115], v13 offset:1952
    ds_read_b64_tr_b16 v[116:117], v13 offset:160
    ds_read_b64_tr_b16 v[118:119], v13 offset:2080
    ds_read_b64_tr_b16 v[120:121], v13 offset:168
    ds_read_b64_tr_b16 v[122:123], v13 offset:2088
    ds_read_b64_tr_b16 v[124:125], v13 offset:176
    ds_read_b64_tr_b16 v[126:127], v13 offset:2096
    v_mov_b32 v14, v12
    s_waitcnt lgkmcnt(0)
L_p1_Q1_loop:
    s_waitcnt lgkmcnt(6)
    v_mfma_f32_16x16x32_bf16 v[32:35], v[112:115], v[128:131], v[32:35]
    ds_read_b128 v[148:151], v14 offset:33792
    v_mfma_f32_16x16x32_bf16 v[36:39], v[112:115], v[132:135], v[36:39]
    ds_read_b128 v[152:155], v14 offset:35840
    v_mfma_f32_16x16x32_bf16 v[40:43], v[112:115], v[136:139], v[40:43]
    ds_read_b128 v[156:159], v14 offset:37888
    v_mfma_f32_16x16x32_bf16 v[44:47], v[112:115], v[140:143], v[44:47]
    ds_read_b128 v[160:163], v14 offset:39936
    v_mfma_f32_16x16x32_bf16 v[96:99], v[112:115], v[144:147], v[96:99]
    ds_read_b128 v[164:167], v14 offset:31744
    s_waitcnt lgkmcnt(9)
    v_mfma_f32_16x16x32_bf16 v[48:51], v[116:119], v[128:131], v[48:51]
    ds_read_b64_tr_b16 v[112:113], v13 offset:15904
    v_mfma_f32_16x16x32_bf16 v[52:55], v[116:119], v[132:135], v[52:55]
    ds_read_b64_tr_b16 v[114:115], v13 offset:17824
    v_mfma_f32_16x16x32_bf16 v[56:59], v[116:119], v[136:139], v[56:59]
    v_mfma_f32_16x16x32_bf16 v[60:63], v[116:119], v[140:143], v[60:63]
    v_mfma_f32_16x16x32_bf16 v[100:103], v[116:119], v[144:147], v[100:103]
    ds_read_b64_tr_b16 v[116:117], v13 offset:16032
    s_waitcnt lgkmcnt(10)
    v_mfma_f32_16x16x32_bf16 v[64:67], v[120:123], v[128:131], v[64:67]
    ds_read_b64_tr_b16 v[118:119], v13 offset:17952
    v_mfma_f32_16x16x32_bf16 v[68:71], v[120:123], v[132:135], v[68:71]
    v_mfma_f32_16x16x32_bf16 v[72:75], v[120:123], v[136:139], v[72:75]
    v_mfma_f32_16x16x32_bf16 v[76:79], v[120:123], v[140:143], v[76:79]
    v_mfma_f32_16x16x32_bf16 v[104:107], v[120:123], v[144:147], v[104:107]
    ds_read_b64_tr_b16 v[120:121], v13 offset:16040
    s_waitcnt lgkmcnt(10)
    v_mfma_f32_16x16x32_bf16 v[80:83], v[124:127], v[128:131], v[80:83]
    ds_read_b64_tr_b16 v[122:123], v13 offset:17960
    v_mfma_f32_16x16x32_bf16 v[84:87], v[124:127], v[132:135], v[84:87]
    v_mfma_f32_16x16x32_bf16 v[88:91], v[124:127], v[136:139], v[88:91]
    v_mfma_f32_16x16x32_bf16 v[92:95], v[124:127], v[140:143], v[92:95]
    v_mfma_f32_16x16x32_bf16 v[108:111], v[124:127], v[144:147], v[108:111]
    ds_read_b64_tr_b16 v[124:125], v13 offset:16048
    ds_read_b64_tr_b16 v[126:127], v13 offset:17968
    s_waitcnt lgkmcnt(6)
    v_mfma_f32_16x16x32_bf16 v[32:35], v[112:115], v[148:151], v[32:35]
    v_mfma_f32_16x16x32_bf16 v[36:39], v[112:115], v[152:155], v[36:39]
    v_mfma_f32_16x16x32_bf16 v[40:43], v[112:115], v[156:159], v[40:43]
    v_mfma_f32_16x16x32_bf16 v[44:47], v[112:115], v[160:163], v[44:47]
    v_mfma_f32_16x16x32_bf16 v[96:99], v[112:115], v[164:167], v[96:99]
    v_add_u32 v14, s45, v11
    v_add_u32 v13, s45, v10
    s_waitcnt lgkmcnt(0)
    s_barrier
    v_mfma_f32_16x16x32_bf16 v[48:51], v[116:119], v[148:151], v[48:51]
    ds_read_b128 v[128:131], v14 offset:33792
    v_mfma_f32_16x16x32_bf16 v[52:55], v[116:119], v[152:155], v[52:55]
    ds_read_b128 v[132:135], v14 offset:35840
    v_mfma_f32_16x16x32_bf16 v[56:59], v[116:119], v[156:159], v[56:59]
    ds_read_b128 v[136:139], v14 offset:37888
    v_mfma_f32_16x16x32_bf16 v[60:63], v[116:119], v[160:163], v[60:63]
    ds_read_b128 v[140:143], v14 offset:39936
    v_mfma_f32_16x16x32_bf16 v[100:103], v[116:119], v[164:167], v[100:103]
    ds_read_b128 v[144:147], v14 offset:31744
    v_mfma_f32_16x16x32_bf16 v[64:67], v[120:123], v[148:151], v[64:67]
    ds_read_b64_tr_b16 v[112:113], v13 offset:32
    v_mfma_f32_16x16x32_bf16 v[68:71], v[120:123], v[152:155], v[68:71]
    ds_read_b64_tr_b16 v[114:115], v13 offset:1952
    v_mfma_f32_16x16x32_bf16 v[72:75], v[120:123], v[156:159], v[72:75]
    ds_read_b64_tr_b16 v[116:117], v13 offset:160
    v_mfma_f32_16x16x32_bf16 v[76:79], v[120:123], v[160:163], v[76:79]
    ds_read_b64_tr_b16 v[118:119], v13 offset:2080
    v_mfma_f32_16x16x32_bf16 v[104:107], v[120:123], v[164:167], v[104:107]
    ds_read_b64_tr_b16 v[120:121], v13 offset:168
    v_mfma_f32_16x16x32_bf16 v[80:83], v[124:127], v[148:151], v[80:83]
    ds_read_b64_tr_b16 v[122:123], v13 offset:2088
    v_mfma_f32_16x16x32_bf16 v[84:87], v[124:127], v[152:155], v[84:87]
    v_mfma_f32_16x16x32_bf16 v[88:91], v[124:127], v[156:159], v[88:91]
    v_mfma_f32_16x16x32_bf16 v[92:95], v[124:127], v[160:163], v[92:95]
    v_mfma_f32_16x16x32_bf16 v[108:111], v[124:127], v[164:167], v[108:111]
    ds_read_b64_tr_b16 v[124:125], v13 offset:176
    ds_read_b64_tr_b16 v[126:127], v13 offset:2096
    v_add_u32 v14, s45, v12
    s_add_u32 s45, s45, 50176
    s_cmp_eq_u32 s45, 150528
    s_cselect_b32 s45, 0, s45
    s_add_u32 s48, s48, 1
    s_cmp_lt_u32 s48, 10
    s_cbranch_scc1 L_p1_Q1_loop
    s_waitcnt lgkmcnt(0)
    s_branch L_epi_Q
L_p1_Q2:
    s_barrier
    ds_read_b128 v[128:131], v14 offset:33792
    ds_read_b128 v[132:135], v14 offset:35840
    ds_read_b128 v[136:139], v14 offset:37888
    ds_read_b128 v[140:143], v14 offset:39936
    ds_read_b128 v[144:147], v14 offset:31744
    ds_read_b64_tr_b16 v[112:113], v13 offset:184
    ds_read_b64_tr_b16 v[114:115], v13 offset:2104
    ds_read_b64_tr_b16 v[116:117], v13 offset:192
    ds_read_b64_tr_b16 v[118:119], v13 offset:2112
    ds_read_b64_tr_b16 v[120:121], v13 offset:320
    ds_read_b64_tr_b16 v[122:123], v13 offset:2240
    ds_read_b64_tr_b16 v[124:125], v13 offset:328
    ds_read_b64_tr_b16 v[126:127], v13 offset:2248
    v_mov_b32 v14, v12
    s_waitcnt lgkmcnt(0)
L_p1_Q2_loop:
    s_waitcnt lgkmcnt(6)
    v_mfma_f32_16x16x32_bf16 v[32:35], v[112:115], v[128:131], v[32:35]
    ds_read_b128 v[148:151], v14 offset:33792
    v_mfma_f32_16x16x32_bf16 v[36:39], v[112:115], v[132:135], v[36:39]
    ds_read_b128 v[152:155], v14 offset:35840
    v_mfma_f32_16x16x32_bf16 v[40:43], v[112:115], v[136:139], v[40:43]
    ds_read_b128 v[156:159], v14 offset:37888
    v_mfma_f32_16x16x32_bf16 v[44:47], v[112:115], v[140:143], v[44:47]
    ds_read_b128 v[160:163], v14 offset:39936
    v_mfma_f32_16x16x32_bf16 v[96:99], v[112:115], v[144:147], v[96:99]
    ds_read_b128 v[164:167], v14 offset:31744
    s_waitcnt lgkmcnt(9)
    v_mfma_f32_16x16x32_bf16 v[48:51], v[116:119], v[128:131], v[48:51]
    ds_read_b64_tr_b16 v[112:113], v13 offset:16056
    v_mfma_f32_16x16x32_bf16 v[52:55], v[116:119], v[132:135], v[52:55]
    ds_read_b64_tr_b16 v[114:115], v13 offset:17976
    v_mfma_f32_16x16x32_bf16 v[56:59], v[116:119], v[136:139], v[56:59]
    v_mfma_f32_16x16x32_bf16 v[60:63], v[116:119], v[140:143], v[60:63]
    v_mfma_f32_16x16x32_bf16 v[100:103], v[116:119], v[144:147], v[100:103]
    ds_read_b64_tr_b16 v[116:117], v13 offset:16064
    s_waitcnt lgkmcnt(10)
    v_mfma_f32_16x16x32_bf16 v[64:67], v[120:123], v[128:131], v[64:67]
    ds_read_b64_tr_b16 v[118:119], v13 offset:17984
    v_mfma_f32_16x16x32_bf16 v[68:71], v[120:123], v[132:135], v[68:71]
    v_mfma_f32_16x16x32_bf16 v[72:75], v[120:123], v[136:139], v[72:75]
    v_mfma_f32_16x16x32_bf16 v[76:79], v[120:123], v[140:143], v[76:79]
    ds_read_b64_tr_b16 v[120:121], v13 offset:16192
    s_waitcnt lgkmcnt(10)
    v_mfma_f32_16x16x32_bf16 v[80:83], v[124:127], v[128:131], v[80:83]
    ds_read_b64_tr_b16 v[122:123], v13 offset:18112
    v_mfma_f32_16x16x32_bf16 v[84:87], v[124:127], v[132:135], v[84:87]
    v_mfma_f32_16x16x32_bf16 v[88:91], v[124:127], v[136:139], v[88:91]
    v_mfma_f32_16x16x32_bf16 v[92:95], v[124:127], v[140:143], v[92:95]
    ds_read_b64_tr_b16 v[124:125], v13 offset:16200
    ds_read_b64_tr_b16 v[126:127], v13 offset:18120
    s_waitcnt lgkmcnt(6)
    v_mfma_f32_16x16x32_bf16 v[32:35], v[112:115], v[148:151], v[32:35]
    v_mfma_f32_16x16x32_bf16 v[36:39], v[112:115], v[152:155], v[36:39]
    v_mfma_f32_16x16x32_bf16 v[40:43], v[112:115], v[156:159], v[40:43]
    v_mfma_f32_16x16x32_bf16 v[44:47], v[112:115], v[160:163], v[44:47]
    v_mfma_f32_16x16x32_bf16 v[96:99], v[112:115], v[164:167], v[96:99]
    v_add_u32 v14, s45, v11
    v_add_u32 v13, s45, v10
    s_waitcnt lgkmcnt(0)
    s_barrier
    v_mfma_f32_16x16x32_bf16 v[48:51], v[116:119], v[148:151], v[48:51]
    ds_read_b128 v[128:131], v14 offset:33792
    v_mfma_f32_16x16x32_bf16 v[52:55], v[116:119], v[152:155], v[52:55]
    ds_read_b128 v[132:135], v14 offset:35840
    v_mfma_f32_16x16x32_bf16 v[56:59], v[116:119], v[156:159], v[56:59]
    ds_read_b128 v[136:139], v14 offset:37888
    v_mfma_f32_16x16x32_bf16 v[60:63], v[116:119], v[160:163], v[60:63]
    ds_read_b128 v[140:143], v14 offset:39936
    v_mfma_f32_16x16x32_bf16 v[100:103], v[116:119], v[164:167], v[100:103]
    ds_read_b128 v[144:147], v14 offset:31744
    v_mfma_f32_16x16x32_bf16 v[64:67], v[120:123], v[148:151], v[64:67]
    ds_read_b64_tr_b16 v[112:113], v13 offset:184
    v_mfma_f32_16x16x32_bf16 v[68:71], v[120:123], v[152:155], v[68:71]
    ds_read_b64_tr_b16 v[114:115], v13 offset:2104
    v_mfma_f32_16x16x32_bf16 v[72:75], v[120:123], v[156:159], v[72:75]
    ds_read_b64_tr_b16 v[116:117], v13 offset:192
    v_mfma_f32_16x16x32_bf16 v[76:79], v[120:123], v[160:163], v[76:79]
    ds_read_b64_tr_b16 v[118:119], v13 offset:2112
    v_mfma_f32_16x16x32_bf16 v[80:83], v[124:127], v[148:151], v[80:83]
    ds_read_b64_tr_b16 v[120:121], v13 offset:320
    v_mfma_f32_16x16x32_bf16 v[84:87], v[124:127], v[152:155], v[84:87]
    ds_read_b64_tr_b16 v[122:123], v13 offset:2240
    v_mfma_f32_16x16x32_bf16 v[88:91], v[124:127], v[156:159], v[88:91]
    v_mfma_f32_16x16x32_bf16 v[92:95], v[124:127], v[160:163], v[92:95]
    ds_read_b64_tr_b16 v[124:125], v13 offset:328
    ds_read_b64_tr_b16 v[126:127], v13 offset:2248
    v_add_u32 v14, s45, v12
    s_add_u32 s45, s45, 50176
    s_cmp_eq_u32 s45, 150528
    s_cselect_b32 s45, 0, s45
    s_add_u32 s48, s48, 1
    s_cmp_lt_u32 s48, 10
    s_cbranch_scc1 L_p1_Q2_loop
    s_waitcnt lgkmcnt(0)
    s_branch L_epi_Q
L_p1_Q3:
    s_barrier
    ds_read_b128 v[128:131], v14 offset:41984
    ds_read_b128 v[132:135], v14 offset:44032
    ds_read_b128 v[136:139], v14 offset:46080
    ds_read_b128 v[140:143], v14 offset:48128
    ds_read_b64_tr_b16 v[112:113], v13 offset:32
    ds_read_b64_tr_b16 v[114:115], v13 offset:1952
    ds_read_b64_tr_b16 v[116:117], v13 offset:160
    ds_read_b64_tr_b16 v[118:119], v13 offset:2080
    ds_read_b64_tr_b16 v[120:121], v13 offset:168
    ds_read_b64_tr_b16 v[122:123], v13 offset:2088
    ds_read_b64_tr_b16 v[124:125], v13 offset:176
    ds_read_b64_tr_b16 v[126:127], v13 offset:2096
    v_mov_b32 v14, v12
    s_waitcnt lgkmcnt(0)
L_p1_Q3_loop:
    s_waitcnt lgkmcnt(6)
    v_mfma_f32_16x16x32_bf16 v[32:35], v[112:115], v[128:131], v[32:35]
    ds_read_b128 v[148:151], v14 offset:41984
    v_mfma_f32_16x16x32_bf16 v[36:39], v[112:115], v[132:135], v[36:39]
    ds_read_b128 v[152:155], v14 offset:44032
    v_mfma_f32_16x16x32_bf16 v[40:43], v[112:115], v[136:139], v[40:43]
    ds_read_b128 v[156:159], v14 offset:46080
    v_mfma_f32_16x16x32_bf16 v[44:47], v[112:115], v[140:143], v[44:47]
    ds_read_b128 v[160:163], v14 offset:48128
    s_waitcnt lgkmcnt(8)
    v_mfma_f32_16x16x32_bf16 v[48:51], v[116:119], v[128:131], v[48:51]
    ds_read_b64_tr_b16 v[112:113], v13 offset:15904
    v_mfma_f32_16x16x32_bf16 v[52:55], v[116:119], v[132:135], v[52:55]
    ds_read_b64_tr_b16 v[114:115], v13 offset:17824
    v_mfma_f32_16x16x32_bf16 v[56:59], v[116:119], v[136:139], v[56:59]
    v_mfma_f32_16x16x32_bf16 v[60:63], v[116:119], v[140:143], v[60:63]
    ds_read_b64_tr_b16 v[116:117], v13 offset:16032
    s_waitcnt lgkmcnt(9)
    v_mfma_f32_16x16x32_bf16 v[64:67], v[120:123], v[128:131], v[64:67]
    ds_read_b64_tr_b16 v[118:119], v13 offset:17952
    v_mfma_f32_16x16x32_bf16 v[68:71], v[120:123], v[132:135], v[68:71]
    v_mfma_f32_16x16x32_bf16 v[72:75], v[120:123], v[136:139], v[72:75]
    v_mfma_f32_16x16x32_bf16 v[76:79], v[120:123], v[140:143], v[76:79]
    ds_read_b64_tr_b16 v[120:121], v13 offset:16040
    s_waitcnt lgkmcnt(9)
    v_mfma_f32_16x16x32_bf16 v[80:83], v[124:127], v[128:131], v[80:83]
    ds_read_b64_tr_b16 v[122:123], v13 offset:17960
    v_mfma_f32_16x16x32_bf16 v[84:87], v[124:127], v[132:135], v[84:87]
    v_mfma_f32_16x16x32_bf16 v[88:91], v[124:127], v[136:139], v[88:91]
    v_mfma_f32_16x16x32_bf16 v[92:95], v[124:127], v[140:143], v[92:95]
    ds_read_b64_tr_b16 v[124:125], v13 offset:16048
    ds_read_b64_tr_b16 v[126:127], v13 offset:17968
    s_waitcnt lgkmcnt(6)
    v_mfma_f32_16x16x32_bf16 v[32:35], v[112:115], v[148:151], v[32:35]
    v_mfma_f32_16x16x32_bf16 v[36:39], v[112:115], v[152:155], v[36:39]
    v_mfma_f32_16x16x32_bf16 v[40:43], v[112:115], v[156:159], v[40:43]
    v_mfma_f32_16x16x32_bf16 v[44:47], v[112:115], v[160:163], v[44:47]
    v_add_u32 v14, s45, v11
    v_add_u32 v13, s45, v10
    s_waitcnt lgkmcnt(0)
    s_barrier
    v_mfma_f32_16x16x32_bf16 v[48:51], v[116:119], v[148:151], v[48:51]
    ds_read_b128 v[128:131], v14 offset:41984
    v_mfma_f32_16x16x32_bf16 v[52:55], v[116:119], v[152:155], v[52:55]
    ds_read_b128 v[132:135], v14 offset:44032
    v_mfma_f32_16x16x32_bf16 v[56:59], v[116:119], v[156:159], v[56:59]
    ds_read_b128 v[136:139], v14 offset:46080
    v_mfma_f32_16x16x32_bf16 v[60:63], v[116:119], v[160:163], v[60:63]
    ds_read_b128 v[140:143], v14 offset:48128
    v_mfma_f32_16x16x32_bf16 v[64:67], v[120:123], v[148:151], v[64:67]
    ds_read_b64_tr_b16 v[112:113], v13 offset:32
    v_mfma_f32_16x16x32_bf16 v[68:71], v[120:123], v[152:155], v[68:71]
    ds_read_b64_tr_b16 v[114:115], v13 offset:1952
    v_mfma_f32_16x16x32_bf16 v[72:75], v[120:123], v[156:159], v[72:75]
    ds_read_b64_tr_b16 v[116:117], v13 offset:160
    v_mfma_f32_16x16x32_bf16 v[76:79], v[120:123], v[160:163], v[76:79]
    ds_read_b64_tr_b16 v[118:119], v13 offset:2080
    v_mfma_f32_16x16x32_bf16 v[80:83], v[124:127], v[148:151], v[80:83]
    ds_read_b64_tr_b16 v[120:121], v13 offset:168
    v_mfma_f32_16x16x32_bf16 v[84:87], v[124:127], v[152:155], v[84:87]
    ds_read_b64_tr_b16 v[122:123], v13 offset:2088
    v_mfma_f32_16x16x32_bf16 v[88:91], v[124:127], v[156:159], v[88:91]
    v_mfma_f32_16x16x32_bf16 v[92:95], v[124:127], v[160:163], v[92:95]
    ds_read_b64_tr_b16 v[124:125], v13 offset:176
    ds_read_b64_tr_b16 v[126:127], v13 offset:2096
    v_add_u32 v14, s45, v12
    s_add_u32 s45, s45, 50176
    s_cmp_eq_u32 s45, 150528
    s_cselect_b32 s45, 0, s45
    s_add_u32 s48, s48, 1
    s_cmp_lt_u32 s48, 10
    s_cbranch_scc1 L_p1_Q3_loop
    s_waitcnt lgkmcnt(0)
    s_branch L_epi_Q
L_p1_Q4:
    s_barrier
    ds_read_b128 v[128:131], v14 offset:33792
    ds_read_b128 v[132:135], v14 offset:35840
    ds_read_b128 v[136:139], v14 offset:37888
    ds_read_b128 v[140:143], v14 offset:39936
    ds_read_b128 v[144:147], v14 offset:31744
    ds_read_b64_tr_b16 v[112:113], v13 offset:336
    ds_read_b64_tr_b16 v[114:115], v13 offset:2256
    ds_read_b64_tr_b16 v[116:117], v13 offset:344
    ds_read_b64_tr_b16 v[118:119], v13 offset:2264
    ds_read_b64_tr_b16 v[120:121], v13 offset:352
    ds_read_b64_tr_b16 v[122:123], v13 offset:2272
    v_mov_b32 v14, v12
    s_waitcnt lgkmcnt(0)
L_p1_Q4_loop:
    s_waitcnt lgkmcnt(4)
    v_mfma_f32_16x16x32_bf16 v[32:35], v[112:115], v[128:131], v[32:35]
    ds_read_b128 v[148:151], v14 offset:33792
    v_mfma_f32_16x16x32_bf16 v[36:39], v[112:115], v[132:135], v[36:39]
    ds_read_b128 v[152:155], v14 offset:35840
    v_mfma_f32_16x16x32_bf16 v[40:43], v[112:115], v[136:139], v[40:43]
    ds_read_b128 v[156:159], v14 offset:37888
    v_mfma_f32_16x16x32_bf16 v[44:47], v[112:115], v[140:143], v[44:47]
    ds_read_b128 v[160:163], v14 offset:39936
    v_mfma_f32_16x16x32_bf16 v[96:99], v[112:115], v[144:147], v[96:99]
    ds_read_b128 v[164:167], v14 offset:31744
    s_waitcnt lgkmcnt(7)
    v_mfma_f32_16x16x32_bf16 v[48:51], v[116:119], v[128:131], v[48:51]
    ds_read_b64_tr_b16 v[112:113], v13 offset:16208
    v_mfma_f32_16x16x32_bf16 v[52:55], v[116:119], v[132:135], v[52:55]
    ds_read_b64_tr_b16 v[114:115], v13 offset:18128
    v_mfma_f32_16x16x32_bf16 v[56:59], v[116:119], v[136:139], v[56:59]
    v_mfma_f32_16x16x32_bf16 v[60:63], v[116:119], v[140:143], v[60:63]
    v_mfma_f32_16x16x32_bf16 v[100:103], v[116:119], v[144:147], v[100:103]
    ds_read_b64_tr_b16 v[116:117], v13 offset:16216
    s_waitcnt lgkmcnt(8)
    v_mfma_f32_16x16x32_bf16 v[64:67], v[120:123], v[128:131], v[64:67]
    ds_read_b64_tr_b16 v[118:119], v13 offset:18136
    v_mfma_f32_16x16x32_bf16 v[68:71], v[120:123], v[132:135], v[68:71]
    v_mfma_f32_16x16x32_bf16 v[72:75], v[120:123], v[136:139], v[72:75]
    v_mfma_f32_16x16x32_bf16 v[76:79], v[120:123], v[140:143], v[76:79]
    ds_read_b64_tr_b16 v[120:121], v13 offset:16224
    ds_read_b64_tr_b16 v[122:123], v13 offset:18144
    s_waitcnt lgkmcnt(4)
    v_mfma_f32_16x16x32_bf16 v[32:35], v[112:115], v[148:151], v[32:35]
    v_mfma_f32_16x16x32_bf16 v[36:39], v[112:115], v[152:155], v[36:39]
    v_mfma_f32_16x16x32_bf16 v[40:43], v[112:115], v[156:159], v[40:43]
    v_mfma_f32_16x16x32_bf16 v[44:47], v[112:115], v[160:163], v[44:47]
    v_mfma_f32_16x16x32_bf16 v[96:99], v[112:115], v[164:167], v[96:99]
    v_add_u32 v14, s45, v11
    v_add_u32 v13, s45, v10
    s_waitcnt lgkmcnt(0)
    s_barrier
    v_mfma_f32_16x16x32_bf16 v[48:51], v[116:119], v[148:151], v[48:51]
    ds_read_b128 v[128:131], v14 offset:33792
    v_mfma_f32_16x16x32_bf16 v[52:55], v[116:119], v[152:155], v[52:55]
    ds_read_b128 v[132:135], v14 offset:35840
    v_mfma_f32_16x16x32_bf16 v[56:59], v[116:119], v[156:159], v[56:59]
    ds_read_b128 v[136:139], v14 offset:37888
    v_mfma_f32_16x16x32_bf16 v[60:63], v[116:119], v[160:163], v[60:63]
    ds_read_b128 v[140:143], v14 offset:39936
    v_mfma_f32_16x16x32_bf16 v[100:103], v[116:119], v[164:167], v[100:103]
    ds_read_b128 v[144:147], v14 offset:31744
    v_mfma_f32_16x16x32_bf16 v[64:67], v[120:123], v[148:151], v[64:67]
    ds_read_b64_tr_b16 v[112:113], v13 offset:336
    v_mfma_f32_16x16x32_bf16 v[68:71], v[120:123], v[152:155], v[68:71]
    ds_read_b64_tr_b16 v[114:115], v13 offset:2256
    v_mfma_f32_16x16x32_bf16 v[72:75], v[120:123], v[156:159], v[72:75]
    ds_read_b64_tr_b16 v[116:117], v13 offset:344
    v_mfma_f32_16x16x32_bf16 v[76:79], v[120:123], v[160:163], v[76:79]
    ds_read_b64_tr_b16 v[118:119], v13 offset:2264
    ds_read_b64_tr_b16 v[120:121], v13 offset:352
    ds_read_b64_tr_b16 v[122:123], v13 offset:2272
    v_add_u32 v14, s45, v12
    s_add_u32 s45, s45, 50176
    s_cmp_eq_u32 s45, 150528
    s_cselect_b32 s45, 0, s45
    s_add_u32 s48, s48, 1
    s_cmp_lt_u32 s48, 10
    s_cbranch_scc1 L_p1_Q4_loop
    s_waitcnt lgkmcnt(0)
    s_branch L_epi_Q
L_p1_Q5:
    s_barrier
    ds_read_b128 v[128:131], v14 offset:41984
    ds_read_b128 v[132:135], v14 offset:44032
    ds_read_b128 v[136:139], v14 offset:46080
    ds_read_b128 v[140:143], v14 offset:48128
    ds_read_b128 v[144:147], v14 offset:31744
    ds_read_b64_tr_b16 v[112:113], v13 offset:336
    ds_read_b64_tr_b16 v[114:115], v13 offset:2256
    ds_read_b64_tr_b16 v[116:117], v13 offset:344
    ds_read_b64_tr_b16 v[118:119], v13 offset:2264
    ds_read_b64_tr_b16 v[120:121], v13 offset:352
    ds_read_b64_tr_b16 v[122:123], v13 offset:2272
    v_mov_b32 v14, v12
    s_waitcnt lgkmcnt(0)
L_p1_Q5_loop:
    s_waitcnt lgkmcnt(4)
    v_mfma_f32_16x16x32_bf16 v[32:35], v[112:115], v[128:131], v[32:35]
    ds_read_b128 v[148:151], v14 offset:41984
    v_mfma_f32_16x16x32_bf16 v[36:39], v[112:115], v[132:135], v[36:39]
    ds_read_b128 v[152:155], v14 offset:44032
    v_mfma_f32_16x16x32_bf16 v[40:43], v[112:115], v[136:139], v[40:43]
    ds_read_b128 v[156:159], v14 offset:46080
    v_mfma_f32_16x16x32_bf16 v[44:47], v[112:115], v[140:143], v[44:47]
    ds_read_b128 v[160:163], v14 offset:48128
    s_waitcnt lgkmcnt(6)
    v_mfma_f32_16x16x32_bf16 v[48:51], v[116:119], v[128:131], v[48:51]
    ds_read_b128 v[164:167], v14 offset:31744
    v_mfma_f32_16x16x32_bf16 v[52:55], v[116:119], v[132:135], v[52:55]
    ds_read_b64_tr_b16 v[112:113], v13 offset:16208
    v_mfma_f32_16x16x32_bf16 v[56:59], v[116:119], v[136:139], v[56:59]
    ds_read_b64_tr_b16 v[114:115], v13 offset:18128
    v_mfma_f32_16x16x32_bf16 v[60:63], v[116:119], v[140:143], v[60:63]
    ds_read_b64_tr_b16 v[116:117], v13 offset:16216
    s_waitcnt lgkmcnt(8)
    v_mfma_f32_16x16x32_bf16 v[64:67], v[120:123], v[128:131], v[64:67]
    ds_read_b64_tr_b16 v[118:119], v13 offset:18136
    v_mfma_f32_16x16x32_bf16 v[68:71], v[120:123], v[132:135], v[68:71]
    v_mfma_f32_16x16x32_bf16 v[72:75], v[120:123], v[136:139], v[72:75]
    v_mfma_f32_16x16x32_bf16 v[76:79], v[120:123], v[140:143], v[76:79]
    v_mfma_f32_16x16x32_bf16 v[96:99], v[120:123], v[144:147], v[96:99]
    ds_read_b64_tr_b16 v[120:121], v13 offset:16224
    ds_read_b64_tr_b16 v[122:123], v13 offset:18144
    s_waitcnt lgkmcnt(4)
    v_mfma_f32_16x16x32_bf16 v[32:35], v[112:115], v[148:151], v[32:35]
    v_mfma_f32_16x16x32_bf16 v[36:39], v[112:115], v[152:155], v[36:39]
    v_mfma_f32_16x16x32_bf16 v[40:43], v[112:115], v[156:159], v[40:43]
    v_mfma_f32_16x16x32_bf16 v[44:47], v[112:115], v[160:163], v[44:47]
    v_add_u32 v14, s45, v11
    v_add_u32 v13, s45, v10
    s_waitcnt lgkmcnt(0)
    s_barrier
    v_mfma_f32_16x16x32_bf16 v[48:51], v[116:119], v[148:151], v[48:51]
    ds_read_b128 v[128:131], v14 offset:41984
    v_mfma_f32_16x16x32_bf16 v[52:55], v[116:119], v[152:155], v[52:55]
    ds_read_b128 v[132:135], v14 offset:44032
    v_mfma_f32_16x16x32_bf16 v[56:59], v[116:119], v[156:159], v[56:59]
    ds_read_b128 v[136:139], v14 offset:46080
    v_mfma_f32_16x16x32_bf16 v[60:63], v[116:119], v[160:163], v[60:63]
    ds_read_b128 v[140:143], v14 offset:48128
    v_mfma_f32_16x16x32_bf16 v[64:67], v[120:123], v[148:151], v[64:67]
    ds_read_b128 v[144:147], v14 offset:31744
    v_mfma_f32_16x16x32_bf16 v[68:71], v[120:123], v[152:155], v[68:71]
    ds_read_b64_tr_b16 v[112:113], v13 offset:336
    v_mfma_f32_16x16x32_bf16 v[72:75], v[120:123], v[156:159], v[72:75]
    ds_read_b64_tr_b16 v[114:115], v13 offset:2256
    v_mfma_f32_16x16x32_bf16 v[76:79], v[120:123], v[160:163], v[76:79]
    ds_read_b64_tr_b16 v[116:117], v13 offset:344
    v_mfma_f32_16x16x32_bf16 v[96:99], v[120:123], v[164:167], v[96:99]
    ds_read_b64_tr_b16 v[118:119], v13 offset:2264
    ds_read_b64_tr_b16 v[120:121], v13 offset:352
    ds_read_b64_tr_b16 v[122:123], v13 offset:2272
    v_add_u32 v14, s45, v12
    s_add_u32 s45, s45, 50176
    s_cmp_eq_u32 s45, 150528
    s_cselect_b32 s45, 0, s45
    s_add_u32 s48, s48, 1
    s_cmp_lt_u32 s48, 10
    s_cbranch_scc1 L_p1_Q5_loop
    s_waitcnt lgkmcnt(0)
    s_branch L_epi_Q
L_p1_Q6:
    s_barrier
    ds_read_b128 v[128:131], v14 offset:41984
    ds_read_b128 v[132:135], v14 offset:44032
    ds_read_b128 v[136:139], v14 offset:46080
    ds_read_b128 v[140:143], v14 offset:48128
    ds_read_b64_tr_b16 v[112:113], v13 offset:0
    ds_read_b64_tr_b16 v[114:115], v13 offset:1920
    ds_read_b64_tr_b16 v[116:117], v13 offset:8
    ds_read_b64_tr_b16 v[118:119], v13 offset:1928
    ds_read_b64_tr_b16 v[120:121], v13 offset:16
    ds_read_b64_tr_b16 v[122:123], v13 offset:1936
    ds_read_b64_tr_b16 v[124:125], v13 offset:24
    ds_read_b64_tr_b16 v[126:127], v13 offset:1944
    v_mov_b32 v14, v12
    s_waitcnt lgkmcnt(0)
L_p1_Q6_loop:
    s_waitcnt lgkmcnt(6)
    v_mfma_f32_16x16x32_bf16 v[32:35], v[112:115], v[128:131], v[32:35]
    ds_read_b128 v[148:151], v14 offset:41984
    v_mfma_f32_16x16x32_bf16 v[36:39], v[112:115], v[132:135], v[36:39]
    ds_read_b128 v[152:155], v14 offset:44032
    v_mfma_f32_16x16x32_bf16 v[40:43], v[112:115], v[136:139], v[40:43]
    ds_read_b128 v[156:159], v14 offset:46080
    v_mfma_f32_16x16x32_bf16 v[44:47], v[112:115], v[140:143], v[44:47]
    ds_read_b128 v[160:163], v14 offset:48128
    s_waitcnt lgkmcnt(8)
    v_mfma_f32_16x16x32_bf16 v[48:51], v[116:119], v[128:131], v[48:51]
    ds_read_b64_tr_b16 v[112:113], v13 offset:15872
    v_mfma_f32_16x16x32_bf16 v[52:55], v[116:119], v[132:135], v[52:55]
    ds_read_b64_tr_b16 v[114:115], v13 offset:17792
    v_mfma_f32_16x16x32_bf16 v[56:59], v[116:119], v[136:139], v[56:59]
    v_mfma_f32_16x16x32_bf16 v[60:63], v[116:119], v[140:143], v[60:63]
    ds_read_b64_tr_b16 v[116:117], v13 offset:15880
    s_waitcnt lgkmcnt(9)
    v_mfma_f32_16x16x32_bf16 v[64:67], v[120:123], v[128:131], v[64:67]
    ds_read_b64_tr_b16 v[118:119], v13 offset:17800
    v_mfma_f32_16x16x32_bf16 v[68:71], v[120:123], v[132:135], v[68:71]
    v_mfma_f32_16x16x32_bf16 v[72:75], v[120:123], v[136:139], v[72:75]
    v_mfma_f32_16x16x32_bf16 v[76:79], v[120:123], v[140:143], v[76:79]
    ds_read_b64_tr_b16 v[120:121], v13 offset:15888
    s_waitcnt lgkmcnt(9)
    v_mfma_f32_16x16x32_bf16 v[80:83], v[124:127], v[128:131], v[80:83]
    ds_read_b64_tr_b16 v[122:123], v13 offset:17808
    v_mfma_f32_16x16x32_bf16 v[84:87], v[124:127], v[132:135], v[84:87]
    v_mfma_f32_16x16x32_bf16 v[88:91], v[124:127], v[136:139], v[88:91]
    v_mfma_f32_16x16x32_bf16 v[92:95], v[124:127], v[140:143], v[92:95]
    ds_read_b64_tr_b16 v[124:125], v13 offset:15896
    ds_read_b64_tr_b16 v[126:127], v13 offset:17816
    s_waitcnt lgkmcnt(6)
    v_mfma_f32_16x16x32_bf16 v[32:35], v[112:115], v[148:151], v[32:35]
    v_mfma_f32_16x16x32_bf16 v[36:39], v[112:115], v[152:155], v[36:39]
    v_mfma_f32_16x16x32_bf16 v[40:43], v[112:115], v[156:159], v[40:43]
    v_mfma_f32_16x16x32_bf16 v[44:47], v[112:115], v[160:163], v[44:47]
    v_add_u32 v14, s45, v11
    v_add_u32 v13, s45, v10
    s_waitcnt lgkmcnt(0)
    s_barrier
    v_mfma_f32_16x16x32_bf16 v[48:51], v[116:119], v[148:151], v[48:51]
    ds_read_b128 v[128:131], v14 offset:41984
    v_mfma_f32_16x16x32_bf16 v[52:55], v[116:119], v[152:155], v[52:55]
    ds_read_b128 v[132:135], v14 offset:44032
    v_mfma_f32_16x16x32_bf16 v[56:59], v[116:119], v[156:159], v[56:59]
    ds_read_b128 v[136:139], v14 offset:46080
    v_mfma_f32_16x16x32_bf16 v[60:63], v[116:119], v[160:163], v[60:63]
    ds_read_b128 v[140:143], v14 offset:48128
    v_mfma_f32_16x16x32_bf16 v[64:67], v[120:123], v[148:151], v[64:67]
    ds_read_b64_tr_b16 v[112:113], v13 offset:0
    v_mfma_f32_16x16x32_bf16 v[68:71], v[120:123], v[152:155], v[68:71]
    ds_read_b64_tr_b16 v[114:115], v13 offset:1920
    v_mfma_f32_16x16x32_bf16 v[72:75], v[120:123], v[156:159], v[72:75]
    ds_read_b64_tr_b16 v[116:117], v13 offset:8
    v_mfma_f32_16x16x32_bf16 v[76:79], v[120:123], v[160:163], v[76:79]
    ds_read_b64_tr_b16 v[118:119], v13 offset:1928
    v_mfma_f32_16x16x32_bf16 v[80:83], v[124:127], v[148:151], v[80:83]
    ds_read_b64_tr_b16 v[120:121], v13 offset:16
    v_mfma_f32_16x16x32_bf16 v[84:87], v[124:127], v[152:155], v[84:87]
    ds_read_b64_tr_b16 v[122:123], v13 offset:1936
    v_mfma_f32_16x16x32_bf16 v[88:91], v[124:127], v[156:159], v[88:91]
    v_mfma_f32_16x16x32_bf16 v[92:95], v[124:127], v[160:163], v[92:95]
    ds_read_b64_tr_b16 v[124:125], v13 offset:24
    ds_read_b64_tr_b16 v[126:127], v13 offset:1944
    v_add_u32 v14, s45, v12
    s_add_u32 s45, s45, 50176
    s_cmp_eq_u32 s45, 150528
    s_cselect_b32 s45, 0, s45
    s_add_u32 s48, s48, 1
    s_cmp_lt_u32 s48, 10
    s_cbranch_scc1 L_p1_Q6_loop
    s_waitcnt lgkmcnt(0)
    s_branch L_epi_Q
L_p1_Q7:
    s_barrier
    ds_read_b128 v[128:131], v14 offset:41984
    ds_read_b128 v[132:135], v14 offset:44032
    ds_read_b128 v[136:139], v14 offset:46080
    ds_read_b128 v[140:143], v14 offset:48128
    ds_read_b128 v[144:147], v14 offset:31744
    ds_read_b64_tr_b16 v[112:113], v13 offset:184
    ds_read_b64_tr_b16 v[114:115], v13 offset:2104
    ds_read_b64_tr_b16 v[116:117], v13 offset:192
    ds_read_b64_tr_b16 v[118:119], v13 offset:2112
    ds_read_b64_tr_b16 v[120:121], v13 offset:320
    ds_read_b64_tr_b16 v[122:123], v13 offset:2240
    ds_read_b64_tr_b16 v[124:125], v13 offset:328
    ds_read_b64_tr_b16 v[126:127], v13 offset:2248
    v_mov_b32 v14, v12
    s_waitcnt lgkmcnt(0)
L_p1_Q7_loop:
    s_waitcnt lgkmcnt(6)
    v_mfma_f32_16x16x32_bf16 v[32:35], v[112:115], v[128:131], v[32:35]
    ds_read_b128 v[148:151], v14 offset:41984
    v_mfma_f32_16x16x32_bf16 v[36:39], v[112:115], v[132:135], v[36:39]
    ds_read_b128 v[152:155], v14 offset:44032
    v_mfma_f32_16x16x32_bf16 v[40:43], v[112:115], v[136:139], v[40:43]
    ds_read_b128 v[156:159], v14 offset:46080
    v_mfma_f32_16x16x32_bf16 v[44:47], v[112:115], v[140:143], v[44:47]
    ds_read_b128 v[160:163], v14 offset:48128
    s_waitcnt lgkmcnt(8)
    v_mfma_f32_16x16x32_bf16 v[48:51], v[116:119], v[128:131], v[48:51]
    ds_read_b128 v[164:167], v14 offset:31744
    v_mfma_f32_16x16x32_bf16 v[52:55], v[116:119], v[132:135], v[52:55]
    ds_read_b64_tr_b16 v[112:113], v13 offset:16056
    v_mfma_f32_16x16x32_bf16 v[56:59], v[116:119], v[136:139], v[56:59]
    ds_read_b64_tr_b16 v[114:115], v13 offset:17976
    v_mfma_f32_16x16x32_bf16 v[60:63], v[116:119], v[140:143], v[60:63]
    ds_read_b64_tr_b16 v[116:117], v13 offset:16064
    s_waitcnt lgkmcnt(10)
    v_mfma_f32_16x16x32_bf16 v[64:67], v[120:123], v[128:131], v[64:67]
    ds_read_b64_tr_b16 v[118:119], v13 offset:17984
    v_mfma_f32_16x16x32_bf16 v[68:71], v[120:123], v[132:135], v[68:71]
    v_mfma_f32_16x16x32_bf16 v[72:75], v[120:123], v[136:139], v[72:75]
    v_mfma_f32_16x16x32_bf16 v[76:79], v[120:123], v[140:143], v[76:79]
    v_mfma_f32_16x16x32_bf16 v[96:99], v[120:123], v[144:147], v[96:99]
    ds_read_b64_tr_b16 v[120:121], v13 offset:16192
    s_waitcnt lgkmcnt(10)
    v_mfma_f32_16x16x32_bf16 v[80:83], v[124:127], v[128:131], v[80:83]
    ds_read_b64_tr_b16 v[122:123], v13 offset:18112
    v_mfma_f32_16x16x32_bf16 v[84:87], v[124:127], v[132:135], v[84:87]
    v_mfma_f32_16x16x32_bf16 v[88:91], v[124:127], v[136:139], v[88:91]
    v_mfma_f32_16x16x32_bf16 v[92:95], v[124:127], v[140:143], v[92:95]
    v_mfma_f32_16x16x32_bf16 v[100:103], v[124:127], v[144:147], v[100:103]
    ds_read_b64_tr_b16 v[124:125], v13 offset:16200
    ds_read_b64_tr_b16 v[126:127], v13 offset:18120
    s_waitcnt lgkmcnt(6)
    v_mfma_f32_16x16x32_bf16 v[32:35], v[112:115], v[148:151], v[32:35]
    v_mfma_f32_16x16x32_bf16 v[36:39], v[112:115], v[152:155], v[36:39]
    v_mfma_f32_16x16x32_bf16 v[40:43], v[112:115], v[156:159], v[40:43]
    v_mfma_f32_16x16x32_bf16 v[44:47], v[112:115], v[160:163], v[44:47]
    v_add_u32 v14, s45, v11
    v_add_u32 v13, s45, v10
    s_waitcnt lgkmcnt(0)
    s_barrier
    v_mfma_f32_16x16x32_bf16 v[48:51], v[116:119], v[148:151], v[48:51]
    ds_read_b128 v[128:131], v14 offset:41984
    v_mfma_f32_16x16x32_bf16 v[52:55], v[116:119], v[152:155], v[52:55]
    ds_read_b128 v[132:135], v14 offset:44032
    v_mfma_f32_16x16x32_bf16 v[56:59], v[116:119], v[156:159], v[56:59]
    ds_read_b128 v[136:139], v14 offset:46080
    v_mfma_f32_16x16x32_bf16 v[60:63], v[116:119], v[160:163], v[60:63]
    ds_read_b128 v[140:143], v14 offset:48128
    v_mfma_f32_16x16x32_bf16 v[64:67], v[120:123], v[148:151], v[64:67]
    ds_read_b128 v[144:147], v14 offset:31744
    v_mfma_f32_16x16x32_bf16 v[68:71], v[120:123], v[152:155], v[68:71]
    ds_read_b64_tr_b16 v[112:113], v13 offset:184
    v_mfma_f32_16x16x32_bf16 v[72:75], v[120:123], v[156:159], v[72:75]
    ds_read_b64_tr_b16 v[114:115], v13 offset:2104
    v_mfma_f32_16x16x32_bf16 v[76:79], v[120:123], v[160:163], v[76:79]
    ds_read_b64_tr_b16 v[116:117], v13 offset:192
    v_mfma_f32_16x16x32_bf16 v[96:99], v[120:123], v[164:167], v[96:99]
    ds_read_b64_tr_b16 v[118:119], v13 offset:2112
    v_mfma_f32_16x16x32_bf16 v[80:83], v[124:127], v[148:151], v[80:83]
    ds_read_b64_tr_b16 v[120:121], v13 offset:320
    v_mfma_f32_16x16x32_bf16 v[84:87], v[124:127], v[152:155], v[84:87]
    ds_read_b64_tr_b16 v[122:123], v13 offset:2240
    v_mfma_f32_16x16x32_bf16 v[88:91], v[124:127], v[156:159], v[88:91]
    v_mfma_f32_16x16x32_bf16 v[92:95], v[124:127], v[160:163], v[92:95]
    v_mfma_f32_16x16x32_bf16 v[100:103], v[124:127], v[164:167], v[100:103]
    ds_read_b64_tr_b16 v[124:125], v13 offset:328
    ds_read_b64_tr_b16 v[126:127], v13 offset:2248
    v_add_u32 v14, s45, v12
    s_add_u32 s45, s45, 50176
    s_cmp_eq_u32 s45, 150528
    s_cselect_b32 s45, 0, s45
    s_add_u32 s48, s48, 1
    s_cmp_lt_u32 s48, 10
    s_cbranch_scc1 L_p1_Q7_loop
    s_waitcnt lgkmcnt(0)
    s_branch L_epi_Q
L_p1_F0:
    s_barrier
    ds_read_b128 v[128:131], v14 offset:27648
    ds_read_b128 v[132:135], v14 offset:29696
    ds_read_b128 v[136:139], v14 offset:31744
    ds_read_b128 v[140:143], v14 offset:33792
    ds_read_b64_tr_b16 v[112:113], v13 offset:0
    ds_read_b64_tr_b16 v[114:115], v13 offset:1664
    ds_read_b64_tr_b16 v[116:117], v13 offset:32
    ds_read_b64_tr_b16 v[118:119], v13 offset:1696
    ds_read_b64_tr_b16 v[120:121], v13 offset:64
    ds_read_b64_tr_b16 v[122:123], v13 offset:1728
    ds_read_b64_tr_b16 v[124:125], v13 offset:96
    ds_read_b64_tr_b16 v[126:127], v13 offset:1760
    v_mov_b32 v14, v12
    s_waitcnt lgkmcnt(0)
L_p1_F0_loop:
    s_waitcnt lgkmcnt(6)
    v_mfma_f32_16x16x32_bf16 v[32:35], v[112:115], v[128:131], v[32:35]
    ds_read_b128 v[148:151], v14 offset:27648
    v_mfma_f32_16x16x32_bf16 v[36:39], v[112:115], v[132:135], v[36:39]
    ds_read_b128 v[152:155], v14 offset:29696
    v_mfma_f32_16x16x32_bf16 v[40:43], v[112:115], v[136:139], v[40:43]
    ds_read_b128 v[156:159], v14 offset:31744
    v_mfma_f32_16x16x32_bf16 v[44:47], v[112:115], v[140:143], v[44:47]
    ds_read_b128 v[160:163], v14 offset:33792
    v_mfma_f32_16x16x32_bf16 v[96:99], v[112:115], v[28:31], v[96:99]
    ds_read_b64_tr_b16 v[112:113], v13 offset:13824
    s_waitcnt lgkmcnt(9)
    v_mfma_f32_16x16x32_bf16 v[48:51], v[116:119], v[128:131], v[48:51]
    ds_read_b64_tr_b16 v[114:115], v13 offset:15488
    v_mfma_f32_16x16x32_bf16 v[52:55], v[116:119], v[132:135], v[52:55]
    v_mfma_f32_16x16x32_bf16 v[56:59], v[116:119], v[136:139], v[56:59]
    v_mfma_f32_16x16x32_bf16 v[60:63], v[116:119], v[140:143], v[60:63]
    v_mfma_f32_16x16x32_bf16 v[100:103], v[116:119], v[28:31], v[100:103]
    ds_read_b64_tr_b16 v[116:117], v13 offset:13856
    s_waitcnt lgkmcnt(9)
    v_mfma_f32_16x16x32_bf16 v[64:67], v[120:123], v[128:131], v[64:67]
    ds_read_b64_tr_b16 v[118:119], v13 offset:15520
    v_mfma_f32_16x16x32_bf16 v[68:71], v[120:123], v[132:135], v[68:71]
    v_mfma_f32_16x16x32_bf16 v[72:75], v[120:123], v[136:139], v[72:75]
    v_mfma_f32_16x16x32_bf16 v[76:79], v[120:123], v[140:143], v[76:79]
    ds_read_b64_tr_b16 v[120:121], v13 offset:13888
    s_waitcnt lgkmcnt(9)
    v_mfma_f32_16x16x32_bf16 v[80:83], v[124:127], v[128:131], v[80:83]
    ds_read_b64_tr_b16 v[122:123], v13 offset:15552
    v_mfma_f32_16x16x32_bf16 v[84:87], v[124:127], v[132:135], v[84:87]
    v_mfma_f32_16x16x32_bf16 v[88:91], v[124:127], v[136:139], v[88:91]
    v_mfma_f32_16x16x32_bf16 v[92:95], v[124:127], v[140:143], v[92:95]
    ds_read_b64_tr_b16 v[124:125], v13 offset:13920
    ds_read_b64_tr_b16 v[126:127], v13 offset:15584
    s_waitcnt lgkmcnt(6)
    v_mfma_f32_16x16x32_bf16 v[32:35], v[112:115], v[148:151], v[32:35]
    v_mfma_f32_16x16x32_bf16 v[36:39], v[112:115], v[152:155], v[36:39]
    v_mfma_f32_16x16x32_bf16 v[40:43], v[112:115], v[156:159], v[40:43]
    v_mfma_f32_16x16x32_bf16 v[44:47], v[112:115], v[160:163], v[44:47]
    v_mfma_f32_16x16x32_bf16 v[96:99], v[112:115], v[28:31], v[96:99]
    v_add_u32 v14, s45, v11
    v_add_u32 v13, s45, v10
    s_waitcnt lgkmcnt(0)
    s_barrier
    v_mfma_f32_16x16x32_bf16 v[48:51], v[116:119], v[148:151], v[48:51]
    ds_read_b128 v[128:131], v14 offset:27648
    v_mfma_f32_16x16x32_bf16 v[52:55], v[116:119], v[152:155], v[52:55]
    ds_read_b128 v[132:135], v14 offset:29696
    v_mfma_f32_16x16x32_bf16 v[56:59], v[116:119], v[156:159], v[56:59]
    ds_read_b128 v[136:139], v14 offset:31744
    v_mfma_f32_16x16x32_bf16 v[60:63], v[116:119], v[160:163], v[60:63]
    ds_read_b128 v[140:143], v14 offset:33792
    v_mfma_f32_16x16x32_bf16 v[100:103], v[116:119], v[28:31], v[100:103]
    ds_read_b64_tr_b16 v[112:113], v13 offset:0
    v_mfma_f32_16x16x32_bf16 v[64:67], v[120:123], v[148:151], v[64:67]
    ds_read_b64_tr_b16 v[114:115], v13 offset:1664
    v_mfma_f32_16x16x32_bf16 v[68:71], v[120:123], v[152:155], v[68:71]
    ds_read_b64_tr_b16 v[116:117], v13 offset:32
    v_mfma_f32_16x16x32_bf16 v[72:75], v[120:123], v[156:159], v[72:75]
    ds_read_b64_tr_b16 v[118:119], v13 offset:1696
    v_mfma_f32_16x16x32_bf16 v[76:79], v[120:123], v[160:163], v[76:79]
    ds_read_b64_tr_b16 v[120:121], v13 offset:64
    v_mfma_f32_16x16x32_bf16 v[80:83], v[124:127], v[148:151], v[80:83]
    ds_read_b64_tr_b16 v[122:123], v13 offset:1728
    v_mfma_f32_16x16x32_bf16 v[84:87], v[124:127], v[152:155], v[84:87]
    v_mfma_f32_16x16x32_bf16 v[88:91], v[124:127], v[156:159], v[88:91]
    v_mfma_f32_16x16x32_bf16 v[92:95], v[124:127], v[160:163], v[92:95]
    ds_read_b64_tr_b16 v[124:125], v13 offset:96
    ds_read_b64_tr_b16 v[126:127], v13 offset:1760
    v_add_u32 v14, s45, v12
    s_add_u32 s45, s45, 44032
    s_cmp_eq_u32 s45, 132096
    s_cselect_b32 s45, 0, s45
    s_add_u32 s48, s48, 1
    s_cmp_lt_u32 s48, 10
    s_cbranch_scc1 L_p1_F0_loop
    s_waitcnt lgkmcnt(0)
    s_branch L_epi_F
L_p1_F1:
    s_barrier
    ds_read_b128 v[128:131], v14 offset:27648
    ds_read_b128 v[132:135], v14 offset:29696
    ds_read_b128 v[136:139], v14 offset:31744
    ds_read_b128 v[140:143], v14 offset:33792
    ds_read_b64_tr_b16 v[112:113], v13 offset:192
    ds_read_b64_tr_b16 v[114:115], v13 offset:1856
    ds_read_b64_tr_b16 v[116:117], v13 offset:224
    ds_read_b64_tr_b16 v[118:119], v13 offset:1888
    ds_read_b64_tr_b16 v[120:121], v13 offset:256
    ds_read_b64_tr_b16 v[122:123], v13 offset:1920
    ds_read_b64_tr_b16 v[124:125], v13 offset:288
    ds_read_b64_tr_b16 v[126:127], v13 offset:1952
    v_mov_b32 v14, v12
    s_waitcnt lgkmcnt(0)
L_p1_F1_loop:
    s_waitcnt lgkmcnt(6)
    v_mfma_f32_16x16x32_bf16 v[32:35], v[112:115], v[128:131], v[32:35]
    ds_read_b128 v[148:151], v14 offset:27648
    v_mfma_f32_16x16x32_bf16 v[36:39], v[112:115], v[132:135], v[36:39]
    ds_read_b128 v[152:155], v14 offset:29696
    v_mfma_f32_16x16x32_bf16 v[40:43], v[112:115], v[136:139], v[40:43]
    ds_read_b128 v[156:159], v14 offset:31744
    v_mfma_f32_16x16x32_bf16 v[44:47], v[112:115], v[140:143], v[44:47]
    ds_read_b128 v[160:163], v14 offset:33792
    v_mfma_f32_16x16x32_bf16 v[96:99], v[112:115], v[28:31], v[96:99]
    ds_read_b64_tr_b16 v[112:113], v13 offset:14016
    s_waitcnt lgkmcnt(9)
    v_mfma_f32_16x16x32_bf16 v[48:51], v[116:119], v[128:131], v[48:51]
    ds_read_b64_tr_b16 v[114:115], v13 offset:15680
    v_mfma_f32_16x16x32_bf16 v[52:55], v[116:119], v[132:135], v[52:55]
    v_mfma_f32_16x16x32_bf16 v[56:59], v[116:119], v[136:139], v[56:59]
    v_mfma_f32_16x16x32_bf16 v[60:63], v[116:119], v[140:143], v[60:63]
    v_mfma_f32_16x16x32_bf16 v[100:103], v[116:119], v[28:31], v[100:103]
    ds_read_b64_tr_b16 v[116:117], v13 offset:14048
    s_waitcnt lgkmcnt(9)
    v_mfma_f32_16x16x32_bf16 v[64:67], v[120:123], v[128:131], v[64:67]
    ds_read_b64_tr_b16 v[118:119], v13 offset:15712
    v_mfma_f32_16x16x32_bf16 v[68:71], v[120:123], v[132:135], v[68:71]
    v_mfma_f32_16x16x32_bf16 v[72:75], v[120:123], v[136:139], v[72:75]
    v_mfma_f32_16x16x32_bf16 v[76:79], v[120:123], v[140:143], v[76:79]
    ds_read_b64_tr_b16 v[120:121], v13 offset:14080
    s_waitcnt lgkmcnt(9)
    v_mfma_f32_16x16x32_bf16 v[80:83], v[124:127], v[128:131], v[80:83]
    ds_read_b64_tr_b16 v[122:123], v13 offset:15744
    v_mfma_f32_16x16x32_bf16 v[84:87], v[124:127], v[132:135], v[84:87]
    v_mfma_f32_16x16x32_bf16 v[88:91], v[124:127], v[136:139], v[88:91]
    v_mfma_f32_16x16x32_bf16 v[92:95], v[124:127], v[140:143], v[92:95]
    ds_read_b64_tr_b16 v[124:125], v13 offset:14112
    ds_read_b64_tr_b16 v[126:127], v13 offset:15776
    s_waitcnt lgkmcnt(6)
    v_mfma_f32_16x16x32_bf16 v[32:35], v[112:115], v[148:151], v[32:35]
    v_mfma_f32_16x16x32_bf16 v[36:39], v[112:115], v[152:155], v[36:39]
    v_mfma_f32_16x16x32_bf16 v[40:43], v[112:115], v[156:159], v[40:43]
    v_mfma_f32_16x16x32_bf16 v[44:47], v[112:115], v[160:163], v[44:47]
    v_mfma_f32_16x16x32_bf16 v[96:99], v[112:115], v[28:31], v[96:99]
    v_add_u32 v14, s45, v11
    v_add_u32 v13, s45, v10
    s_waitcnt lgkmcnt(0)
    s_barrier
    v_mfma_f32_16x16x32_bf16 v[48:51], v[116:119], v[148:151], v[48:51]
    ds_read_b128 v[128:131], v14 offset:27648
    v_mfma_f32_16x16x32_bf16 v[52:55], v[116:119], v[152:155], v[52:55]
    ds_read_b128 v[132:135], v14 offset:29696
    v_mfma_f32_16x16x32_bf16 v[56:59], v[116:119], v[156:159], v[56:59]
    ds_read_b128 v[136:139], v14 offset:31744
    v_mfma_f32_16x16x32_bf16 v[60:63], v[116:119], v[160:163], v[60:63]
    ds_read_b128 v[140:143], v14 offset:33792
    v_mfma_f32_16x16x32_bf16 v[100:103], v[116:119], v[28:31], v[100:103]
    ds_read_b64_tr_b16 v[112:113], v13 offset:192
    v_mfma_f32_16x16x32_bf16 v[64:67], v[120:123], v[148:151], v[64:67]
    ds_read_b64_tr_b16 v[114:115], v13 offset:1856
    v_mfma_f32_16x16x32_bf16 v[68:71], v[120:123], v[152:155], v[68:71]
    ds_read_b64_tr_b16 v[116:117], v13 offset:224
    v_mfma_f32_16x16x32_bf16 v[72:75], v[120:123], v[156:159], v[72:75]
    ds_read_b64_tr_b16 v[118:119], v13 offset:1888
    v_mfma_f32_16x16x32_bf16 v[76:79], v[120:123], v[160:163], v[76:79]
    ds_read_b64_tr_b16 v[120:121], v13 offset:256
    v_mfma_f32_16x16x32_bf16 v[80:83], v[124:127], v[148:151], v[80:83]
    ds_read_b64_tr_b16 v[122:123], v13 offset:1920
    v_mfma_f32_16x16x32_bf16 v[84:87], v[124:127], v[152:155], v[84:87]
    v_mfma_f32_16x16x32_bf16 v[88:91], v[124:127], v[156:159], v[88:91]
    v_mfma_f32_16x16x32_bf16 v[92:95], v[124:127], v[160:163], v[92:95]
    ds_read_b64_tr_b16 v[124:125], v13 offset:288
    ds_read_b64_tr_b16 v[126:127], v13 offset:1952
    v_add_u32 v14, s45, v12
    s_add_u32 s45, s45, 44032
    s_cmp_eq_u32 s45, 132096
    s_cselect_b32 s45, 0, s45
    s_add_u32 s48, s48, 1
    s_cmp_lt_u32 s48, 10
    s_cbranch_scc1 L_p1_F1_loop
    s_waitcnt lgkmcnt(0)
    s_branch L_epi_F
L_p1_F2:
    s_barrier
    ds_read_b128 v[128:131], v14 offset:35840
    ds_read_b128 v[132:135], v14 offset:37888
    ds_read_b128 v[136:139], v14 offset:39936
    ds_read_b128 v[140:143], v14 offset:41984
    ds_read_b64_tr_b16 v[112:113], v13 offset:0
    ds_read_b64_tr_b16 v[114:115], v13 offset:1664
    ds_read_b64_tr_b16 v[116:117], v13 offset:32
    ds_read_b64_tr_b16 v[118:119], v13 offset:1696
    ds_read_b64_tr_b16 v[120:121], v13 offset:64
    ds_read_b64_tr_b16 v[122:123], v13 offset:1728
    ds_read_b64_tr_b16 v[124:125], v13 offset:96
    ds_read_b64_tr_b16 v[126:127], v13 offset:1760
    v_mov_b32 v14, v12
    s_waitcnt lgkmcnt(0)
L_p1_F2_loop:
    s_waitcnt lgkmcnt(6)
    v_mfma_f32_16x16x32_bf16 v[32:35], v[112:115], v[128:131], v[32:35]
    ds_read_b128 v[148:151], v14 offset:35840
    v_mfma_f32_16x16x32_bf16 v[36:39], v[112:115], v[132:135], v[36:39]
    ds_read_b128 v[152:155], v14 offset:37888
    v_mfma_f32_16x16x32_bf16 v[40:43], v[112:115], v[136:139], v[40:43]
    ds_read_b128 v[156:159], v14 offset:39936
    v_mfma_f32_16x16x32_bf16 v[44:47], v[112:115], v[140:143], v[44:47]
    ds_read_b128 v[160:163], v14 offset:41984
    s_waitcnt lgkmcnt(8)
    v_mfma_f32_16x16x32_bf16 v[48:51], v[116:119], v[128:131], v[48:51]
    ds_read_b64_tr_b16 v[112:113], v13 offset:13824
    v_mfma_f32_16x16x32_bf16 v[52:55], v[116:119], v[132:135], v[52:55]
    ds_read_b64_tr_b16 v[114:115], v13 offset:15488
    v_mfma_f32_16x16x32_bf16 v[56:59], v[116:119], v[136:139], v[56:59]
    v_mfma_f32_16x16x32_bf16 v[60:63], v[116:119], v[140:143], v[60:63]
    ds_read_b64_tr_b16 v[116:117], v13 offset:13856
    s_waitcnt lgkmcnt(9)
    v_mfma_f32_16x16x32_bf16 v[64:67], v[120:123], v[128:131], v[64:67]
    ds_read_b64_tr_b16 v[118:119], v13 offset:15520
    v_mfma_f32_16x16x32_bf16 v[68:71], v[120:123], v[132:135], v[68:71]
    v_mfma_f32_16x16x32_bf16 v[72:75], v[120:123], v[136:139], v[72:75]
    v_mfma_f32_16x16x32_bf16 v[76:79], v[120:123], v[140:143], v[76:79]
    v_mfma_f32_16x16x32_bf16 v[96:99], v[120:123], v[28:31], v[96:99]
    ds_read_b64_tr_b16 v[120:121], v13 offset:13888
    s_waitcnt lgkmcnt(9)
    v_mfma_f32_16x16x32_bf16 v[80:83], v[124:127], v[128:131], v[80:83]
    ds_read_b64_tr_b16 v[122:123], v13 offset:15552
    v_mfma_f32_16x16x32_bf16 v[84:87], v[124:127], v[132:135], v[84:87]
    v_mfma_f32_16x16x32_bf16 v[88:91], v[124:127], v[136:139], v[88:91]
    v_mfma_f32_16x16x32_bf16 v[92:95], v[124:127], v[140:143], v[92:95]
    v_mfma_f32_16x16x32_bf16 v[100:103], v[124:127], v[28:31], v[100:103]
    ds_read_b64_tr_b16 v[124:125], v13 offset:13920
    ds_read_b64_tr_b16 v[126:127], v13 offset:15584
    s_waitcnt lgkmcnt(6)
    v_mfma_f32_16x16x32_bf16 v[32:35], v[112:115], v[148:151], v[32:35]
    v_mfma_f32_16x16x32_bf16 v[36:39], v[112:115], v[152:155], v[36:39]
    v_mfma_f32_16x16x32_bf16 v[40:43], v[112:115], v[156:159], v[40:43]
    v_mfma_f32_16x16x32_bf16 v[44:47], v[112:115], v[160:163], v[44:47]
    v_add_u32 v14, s45, v11
    v_add_u32 v13, s45, v10
    s_waitcnt lgkmcnt(0)
    s_barrier
    v_mfma_f32_16x16x32_bf16 v[48:51], v[116:119], v[148:151], v[48:51]
    ds_read_b128 v[128:131], v14 offset:35840
    v_mfma_f32_16x16x32_bf16 v[52:55], v[116:119], v[152:155], v[52:55]
    ds_read_b128 v[132:135], v14 offset:37888
    v_mfma_f32_16x16x32_bf16 v[56:59], v[116:119], v[156:159], v[56:59]
    ds_read_b128 v[136:139], v14 offset:39936
    v_mfma_f32_16x16x32_bf16 v[60:63], v[116:119], v[160:163], v[60:63]
    ds_read_b128 v[140:143], v14 offset:41984
    v_mfma_f32_16x16x32_bf16 v[64:67], v[120:123], v[148:151], v[64:67]
    ds_read_b64_tr_b16 v[112:113], v13 offset:0
    v_mfma_f32_16x16x32_bf16 v[68:71], v[120:123], v[152:155], v[68:71]
    ds_read_b64_tr_b16 v[114:115], v13 offset:1664
    v_mfma_f32_16x16x32_bf16 v[72:75], v[120:123], v[156:159], v[72:75]
    ds_read_b64_tr_b16 v[116:117], v13 offset:32
    v_mfma_f32_16x16x32_bf16 v[76:79], v[120:123], v[160:163], v[76:79]
    ds_read_b64_tr_b16 v[118:119], v13 offset:1696
    v_mfma_f32_16x16x32_bf16 v[96:99], v[120:123], v[28:31], v[96:99]
    ds_read_b64_tr_b16 v[120:121], v13 offset:64
    v_mfma_f32_16x16x32_bf16 v[80:83], v[124:127], v[148:151], v[80:83]
    ds_read_b64_tr_b16 v[122:123], v13 offset:1728
    v_mfma_f32_16x16x32_bf16 v[84:87], v[124:127], v[152:155], v[84:87]
    v_mfma_f32_16x16x32_bf16 v[88:91], v[124:127], v[156:159], v[88:91]
    v_mfma_f32_16x16x32_bf16 v[92:95], v[124:127], v[160:163], v[92:95]
    v_mfma_f32_16x16x32_bf16 v[100:103], v[124:127], v[28:31], v[100:103]
    ds_read_b64_tr_b16 v[124:125], v13 offset:96
    ds_read_b64_tr_b16 v[126:127], v13 offset:1760
    v_add_u32 v14, s45, v12
    s_add_u32 s45, s45, 44032
    s_cmp_eq_u32 s45, 132096
    s_cselect_b32 s45, 0, s45
    s_add_u32 s48, s48, 1
    s_cmp_lt_u32 s48, 10
    s_cbranch_scc1 L_p1_F2_loop
    s_waitcnt lgkmcnt(0)
    s_branch L_epi_F
L_p1_F3:
    s_barrier
    ds_read_b128 v[128:131], v14 offset:35840
    ds_read_b128 v[132:135], v14 offset:37888
    ds_read_b128 v[136:139], v14 offset:39936
    ds_read_b128 v[140:143], v14 offset:41984
    ds_read_b64_tr_b16 v[112:113], v13 offset:192
    ds_read_b64_tr_b16 v[114:115], v13 offset:1856
    ds_read_b64_tr_b16 v[116:117], v13 offset:224
    ds_read_b64_tr_b16 v[118:119], v13 offset:1888
    ds_read_b64_tr_b16 v[120:121], v13 offset:256
    ds_read_b64_tr_b16 v[122:123], v13 offset:1920
    ds_read_b64_tr_b16 v[124:125], v13 offset:288
    ds_read_b64_tr_b16 v[126:127], v13 offset:1952
    v_mov_b32 v14, v12
    s_waitcnt lgkmcnt(0)
L_p1_F3_loop:
    s_waitcnt lgkmcnt(6)
    v_mfma_f32_16x16x32_bf16 v[32:35], v[112:115], v[128:131], v[32:35]
    ds_read_b128 v[148:151], v14 offset:35840
    v_mfma_f32_16x16x32_bf16 v[36:39], v[112:115], v[132:135], v[36:39]
    ds_read_b128 v[152:155], v14 offset:37888
    v_mfma_f32_16x16x32_bf16 v[40:43], v[112:115], v[136:139], v[40:43]
    ds_read_b128 v[156:159], v14 offset:39936
    v_mfma_f32_16x16x32_bf16 v[44:47], v[112:115], v[140:143], v[44:47]
    ds_read_b128 v[160:163], v14 offset:41984
    s_waitcnt lgkmcnt(8)
    v_mfma_f32_16x16x32_bf16 v[48:51], v[116:119], v[128:131], v[48:51]
    ds_read_b64_tr_b16 v[112:113], v13 offset:14016
    v_mfma_f32_16x16x32_bf16 v[52:55], v[116:119], v[132:135], v[52:55]
    ds_read_b64_tr_b16 v[114:115], v13 offset:15680
    v_mfma_f32_16x16x32_bf16 v[56:59], v[116:119], v[136:139], v[56:59]
    v_mfma_f32_16x16x32_bf16 v[60:63], v[116:119], v[140:143], v[60:63]
    ds_read_b64_tr_b16 v[116:117], v13 offset:14048
    s_waitcnt lgkmcnt(9)
    v_mfma_f32_16x16x32_bf16 v[64:67], v[120:123], v[128:131], v[64:67]
    ds_read_b64_tr_b16 v[118:119], v13 offset:15712
    v_mfma_f32_16x16x32_bf16 v[68:71], v[120:123], v[132:135], v[68:71]
    v_mfma_f32_16x16x32_bf16 v[72:75], v[120:123], v[136:139], v[72:75]
    v_mfma_f32_16x16x32_bf16 v[76:79], v[120:123], v[140:143], v[76:79]
    v_mfma_f32_16x16x32_bf16 v[96:99], v[120:123], v[28:31], v[96:99]
    ds_read_b64_tr_b16 v[120:121], v13 offset:14080
    s_waitcnt lgkmcnt(9)
    v_mfma_f32_16x16x32_bf16 v[80:83], v[124:127], v[128:131], v[80:83]
    ds_read_b64_tr_b16 v[122:123], v13 offset:15744
    v_mfma_f32_16x16x32_bf16 v[84:87], v[124:127], v[132:135], v[84:87]
    v_mfma_f32_16x16x32_bf16 v[88:91], v[124:127], v[136:139], v[88:91]
    v_mfma_f32_16x16x32_bf16 v[92:95], v[124:127], v[140:143], v[92:95]
    v_mfma_f32_16x16x32_bf16 v[100:103], v[124:127], v[28:31], v[100:103]
    ds_read_b64_tr_b16 v[124:125], v13 offset:14112
    ds_read_b64_tr_b16 v[126:127], v13 offset:15776
    s_waitcnt lgkmcnt(6)
    v_mfma_f32_16x16x32_bf16 v[32:35], v[112:115], v[148:151], v[32:35]
    v_mfma_f32_16x16x32_bf16 v[36:39], v[112:115], v[152:155], v[36:39]
    v_mfma_f32_16x16x32_bf16 v[40:43], v[112:115], v[156:159], v[40:43]
    v_mfma_f32_16x16x32_bf16 v[44:47], v[112:115], v[160:163], v[44:47]
    v_add_u32 v14, s45, v11
    v_add_u32 v13, s45, v10
    s_waitcnt lgkmcnt(0)
    s_barrier
    v_mfma_f32_16x16x32_bf16 v[48:51], v[116:119], v[148:151], v[48:51]
    ds_read_b128 v[128:131], v14 offset:35840
    v_mfma_f32_16x16x32_bf16 v[52:55], v[116:119], v[152:155], v[52:55]
    ds_read_b128 v[132:135], v14 offset:37888
    v_mfma_f32_16x16x32_bf16 v[56:59], v[116:119], v[156:159], v[56:59]
    ds_read_b128 v[136:139], v14 offset:39936
    v_mfma_f32_16x16x32_bf16 v[60:63], v[116:119], v[160:163], v[60:63]
    ds_read_b128 v[140:143], v14 offset:41984
    v_mfma_f32_16x16x32_bf16 v[64:67], v[120:123], v[148:151], v[64:67]
    ds_read_b64_tr_b16 v[112:113], v13 offset:192
    v_mfma_f32_16x16x32_bf16 v[68:71], v[120:123], v[152:155], v[68:71]
    ds_read_b64_tr_b16 v[114:115], v13 offset:1856
    v_mfma_f32_16x16x32_bf16 v[72:75], v[120:123], v[156:159], v[72:75]
    ds_read_b64_tr_b16 v[116:117], v13 offset:224
    v_mfma_f32_16x16x32_bf16 v[76:79], v[120:123], v[160:163], v[76:79]
    ds_read_b64_tr_b16 v[118:119], v13 offset:1888
    v_mfma_f32_16x16x32_bf16 v[96:99], v[120:123], v[28:31], v[96:99]
    ds_read_b64_tr_b16 v[120:121], v13 offset:256
    v_mfma_f32_16x16x32_bf16 v[80:83], v[124:127], v[148:151], v[80:83]
    ds_read_b64_tr_b16 v[122:123], v13 offset:1920
    v_mfma_f32_16x16x32_bf16 v[84:87], v[124:127], v[152:155], v[84:87]
    v_mfma_f32_16x16x32_bf16 v[88:91], v[124:127], v[156:159], v[88:91]
    v_mfma_f32_16x16x32_bf16 v[92:95], v[124:127], v[160:163], v[92:95]
    v_mfma_f32_16x16x32_bf16 v[100:103], v[124:127], v[28:31], v[100:103]
    ds_read_b64_tr_b16 v[124:125], v13 offset:288
    ds_read_b64_tr_b16 v[126:127], v13 offset:1952
    v_add_u32 v14, s45, v12
    s_add_u32 s45, s45, 44032
    s_cmp_eq_u32 s45, 132096
    s_cselect_b32 s45, 0, s45
    s_add_u32 s48, s48, 1
    s_cmp_lt_u32 s48, 10
    s_cbranch_scc1 L_p1_F3_loop
    s_waitcnt lgkmcnt(0)
    s_branch L_epi_F
L_p1_F4:
    s_barrier
    ds_read_b128 v[128:131], v14 offset:27648
    ds_read_b128 v[132:135], v14 offset:29696
    ds_read_b128 v[136:139], v14 offset:31744
    ds_read_b128 v[140:143], v14 offset:33792
    ds_read_b64_tr_b16 v[112:113], v13 offset:128
    ds_read_b64_tr_b16 v[114:115], v13 offset:1792
    ds_read_b64_tr_b16 v[116:117], v13 offset:160
    ds_read_b64_tr_b16 v[118:119], v13 offset:1824
    v_mov_b32 v14, v12
    s_waitcnt lgkmcnt(0)
L_p1_F4_loop:
    s_waitcnt lgkmcnt(2)
    v_mfma_f32_16x16x32_bf16 v[32:35], v[112:115], v[128:131], v[32:35]
    ds_read_b128 v[148:151], v14 offset:27648
    v_mfma_f32_16x16x32_bf16 v[36:39], v[112:115], v[132:135], v[36:39]
    ds_read_b128 v[152:155], v14 offset:29696
    v_mfma_f32_16x16x32_bf16 v[40:43], v[112:115], v[136:139], v[40:43]
    ds_read_b128 v[156:159], v14 offset:31744
    v_mfma_f32_16x16x32_bf16 v[44:47], v[112:115], v[140:143], v[44:47]
    ds_read_b128 v[160:163], v14 offset:33792
    v_mfma_f32_16x16x32_bf16 v[96:99], v[112:115], v[28:31], v[96:99]
    ds_read_b64_tr_b16 v[112:113], v13 offset:13952
    s_waitcnt lgkmcnt(5)
    v_mfma_f32_16x16x32_bf16 v[48:51], v[116:119], v[128:131], v[48:51]
    ds_read_b64_tr_b16 v[114:115], v13 offset:15616
    v_mfma_f32_16x16x32_bf16 v[52:55], v[116:119], v[132:135], v[52:55]
    v_mfma_f32_16x16x32_bf16 v[56:59], v[116:119], v[136:139], v[56:59]
    v_mfma_f32_16x16x32_bf16 v[60:63], v[116:119], v[140:143], v[60:63]
    ds_read_b64_tr_b16 v[116:117], v13 offset:13984
    ds_read_b64_tr_b16 v[118:119], v13 offset:15648
    s_waitcnt lgkmcnt(2)
    v_mfma_f32_16x16x32_bf16 v[32:35], v[112:115], v[148:151], v[32:35]
    v_mfma_f32_16x16x32_bf16 v[36:39], v[112:115], v[152:155], v[36:39]
    v_mfma_f32_16x16x32_bf16 v[40:43], v[112:115], v[156:159], v[40:43]
    v_mfma_f32_16x16x32_bf16 v[44:47], v[112:115], v[160:163], v[44:47]
    v_mfma_f32_16x16x32_bf16 v[96:99], v[112:115], v[28:31], v[96:99]
    v_add_u32 v14, s45, v11
    v_add_u32 v13, s45, v10
    s_cmp_gt_u32 s48, 6
    s_cbranch_scc1 L_p1_F4_nt
    s_call_b64 s[96:97], L_task
L_p1_F4_nt:
    s_waitcnt lgkmcnt(0)
    s_barrier
    v_mfma_f32_16x16x32_bf16 v[48:51], v[116:119], v[148:151], v[48:51]
    ds_read_b128 v[128:131], v14 offset:27648
    ds_read_b128 v[132:135], v14 offset:29696
    v_mfma_f32_16x16x32_bf16 v[52:55], v[116:119], v[152:155], v[52:55]
    ds_read_b128 v[136:139], v14 offset:31744
    ds_read_b128 v[140:143], v14 offset:33792
    v_mfma_f32_16x16x32_bf16 v[56:59], v[116:119], v[156:159], v[56:59]
    ds_read_b64_tr_b16 v[112:113], v13 offset:128
    v_mfma_f32_16x16x32_bf16 v[60:63], v[116:119], v[160:163], v[60:63]
    ds_read_b64_tr_b16 v[114:115], v13 offset:1792
    ds_read_b64_tr_b16 v[116:117], v13 offset:160
    ds_read_b64_tr_b16 v[118:119], v13 offset:1824
    v_add_u32 v14, s45, v12
    s_add_u32 s45, s45, 44032
    s_cmp_eq_u32 s45, 132096
    s_cselect_b32 s45, 0, s45
    s_add_u32 s48, s48, 1
    s_cmp_lt_u32 s48, 10
    s_cbranch_scc1 L_p1_F4_loop
    s_waitcnt lgkmcnt(0)
    s_branch L_epi_F
L_p1_F5:
    s_barrier
    ds_read_b128 v[128:131], v14 offset:27648
    ds_read_b128 v[132:135], v14 offset:29696
    ds_read_b128 v[136:139], v14 offset:31744
    ds_read_b128 v[140:143], v14 offset:33792
    ds_read_b64_tr_b16 v[112:113], v13 offset:320
    ds_read_b64_tr_b16 v[114:115], v13 offset:1984
    ds_read_b64_tr_b16 v[116:117], v13 offset:352
    ds_read_b64_tr_b16 v[118:119], v13 offset:2016
    v_mov_b32 v14, v12
    s_waitcnt lgkmcnt(0)
L_p1_F5_loop:
    s_waitcnt lgkmcnt(2)
    v_mfma_f32_16x16x32_bf16 v[32:35], v[112:115], v[128:131], v[32:35]
    ds_read_b128 v[148:151], v14 offset:27648
    v_mfma_f32_16x16x32_bf16 v[36:39], v[112:115], v[132:135], v[36:39]
    ds_read_b128 v[152:155], v14 offset:29696
    v_mfma_f32_16x16x32_bf16 v[40:43], v[112:115], v[136:139], v[40:43]
    ds_read_b128 v[156:159], v14 offset:31744
    v_mfma_f32_16x16x32_bf16 v[44:47], v[112:115], v[140:143], v[44:47]
    ds_read_b128 v[160:163], v14 offset:33792
    v_mfma_f32_16x16x32_bf16 v[96:99], v[112:115], v[28:31], v[96:99]
    ds_read_b64_tr_b16 v[112:113], v13 offset:14144
    s_waitcnt lgkmcnt(5)
    v_mfma_f32_16x16x32_bf16 v[48:51], v[116:119], v[128:131], v[48:51]
    ds_read_b64_tr_b16 v[114:115], v13 offset:15808
    v_mfma_f32_16x16x32_bf16 v[52:55], v[116:119], v[132:135], v[52:55]
    v_mfma_f32_16x16x32_bf16 v[56:59], v[116:119], v[136:139], v[56:59]
    v_mfma_f32_16x16x32_bf16 v[60:63], v[116:119], v[140:143], v[60:63]
    ds_read_b64_tr_b16 v[116:117], v13 offset:14176
    ds_read_b64_tr_b16 v[118:119], v13 offset:15840
    s_waitcnt lgkmcnt(2)
    v_mfma_f32_16x16x32_bf16 v[32:35], v[112:115], v[148:151], v[32:35]
    v_mfma_f32_16x16x32_bf16 v[36:39], v[112:115], v[152:155], v[36:39]
    v_mfma_f32_16x16x32_bf16 v[40:43], v[112:115], v[156:159], v[40:43]
    v_mfma_f32_16x16x32_bf16 v[44:47], v[112:115], v[160:163], v[44:47]
    v_mfma_f32_16x16x32_bf16 v[96:99], v[112:115], v[28:31], v[96:99]
    v_add_u32 v14, s45, v11
    v_add_u32 v13, s45, v10
    s_cmp_gt_u32 s48, 6
    s_cbranch_scc1 L_p1_F5_nt
    s_call_b64 s[96:97], L_task
L_p1_F5_nt:
    s_waitcnt lgkmcnt(0)
    s_barrier
    v_mfma_f32_16x16x32_bf16 v[48:51], v[116:119], v[148:151], v[48:51]
    ds_read_b128 v[128:131], v14 offset:27648
    ds_read_b128 v[132:135], v14 offset:29696
    v_mfma_f32_16x16x32_bf16 v[52:55], v[116:119], v[152:155], v[52:55]
    ds_read_b128 v[136:139], v14 offset:31744
    ds_read_b128 v[140:143], v14 offset:33792
    v_mfma_f32_16x16x32_bf16 v[56:59], v[116:119], v[156:159], v[56:59]
    ds_read_b64_tr_b16 v[112:113], v13 offset:320
    v_mfma_f32_16x16x32_bf16 v[60:63], v[116:119], v[160:163], v[60:63]
    ds_read_b64_tr_b16 v[114:115], v13 offset:1984
    ds_read_b64_tr_b16 v[116:117], v13 offset:352
    ds_read_b64_tr_b16 v[118:119], v13 offset:2016
    v_add_u32 v14, s45, v12
    s_add_u32 s45, s45, 44032
    s_cmp_eq_u32 s45, 132096
    s_cselect_b32 s45, 0, s45
    s_add_u32 s48, s48, 1
    s_cmp_lt_u32 s48, 10
    s_cbranch_scc1 L_p1_F5_loop
    s_waitcnt lgkmcnt(0)
    s_branch L_epi_F
L_p1_F6:
    s_barrier
    ds_read_b128 v[128:131], v14 offset:35840
    ds_read_b128 v[132:135], v14 offset:37888
    ds_read_b128 v[136:139], v14 offset:39936
    ds_read_b128 v[140:143], v14 offset:41984
    ds_read_b64_tr_b16 v[112:113], v13 offset:128
    ds_read_b64_tr_b16 v[114:115], v13 offset:1792
    ds_read_b64_tr_b16 v[116:117], v13 offset:160
    ds_read_b64_tr_b16 v[118:119], v13 offset:1824
    v_mov_b32 v14, v12
    s_waitcnt lgkmcnt(0)
L_p1_F6_loop:
    s_waitcnt lgkmcnt(2)
    v_mfma_f32_16x16x32_bf16 v[32:35], v[112:115], v[128:131], v[32:35]
    ds_read_b128 v[148:151], v14 offset:35840
    v_mfma_f32_16x16x32_bf16 v[36:39], v[112:115], v[132:135], v[36:39]
    ds_read_b128 v[152:155], v14 offset:37888
    v_mfma_f32_16x16x32_bf16 v[40:43], v[112:115], v[136:139], v[40:43]
    ds_read_b128 v[156:159], v14 offset:39936
    v_mfma_f32_16x16x32_bf16 v[44:47], v[112:115], v[140:143], v[44:47]
    ds_read_b128 v[160:163], v14 offset:41984
    s_waitcnt lgkmcnt(4)
    v_mfma_f32_16x16x32_bf16 v[48:51], v[116:119], v[128:131], v[48:51]
    ds_read_b64_tr_b16 v[112:113], v13 offset:13952
    v_mfma_f32_16x16x32_bf16 v[52:55], v[116:119], v[132:135], v[52:55]
    ds_read_b64_tr_b16 v[114:115], v13 offset:15616
    v_mfma_f32_16x16x32_bf16 v[56:59], v[116:119], v[136:139], v[56:59]
    v_mfma_f32_16x16x32_bf16 v[60:63], v[116:119], v[140:143], v[60:63]
    v_mfma_f32_16x16x32_bf16 v[96:99], v[116:119], v[28:31], v[96:99]
    ds_read_b64_tr_b16 v[116:117], v13 offset:13984
    ds_read_b64_tr_b16 v[118:119], v13 offset:15648
    s_waitcnt lgkmcnt(2)
    v_mfma_f32_16x16x32_bf16 v[32:35], v[112:115], v[148:151], v[32:35]
    v_mfma_f32_16x16x32_bf16 v[36:39], v[112:115], v[152:155], v[36:39]
    v_mfma_f32_16x16x32_bf16 v[40:43], v[112:115], v[156:159], v[40:43]
    v_mfma_f32_16x16x32_bf16 v[44:47], v[112:115], v[160:163], v[44:47]
    v_add_u32 v14, s45, v11
    v_add_u32 v13, s45, v10
    s_cmp_gt_u32 s48, 6
    s_cbranch_scc1 L_p1_F6_nt
    s_call_b64 s[96:97], L_task
L_p1_F6_nt:
    s_waitcnt lgkmcnt(0)
    s_barrier
    v_mfma_f32_16x16x32_bf16 v[48:51], v[116:119], v[148:151], v[48:51]
    ds_read_b128 v[128:131], v14 offset:35840
    ds_read_b128 v[132:135], v14 offset:37888
    v_mfma_f32_16x16x32_bf16 v[52:55], v[116:119], v[152:155], v[52:55]
    ds_read_b128 v[136:139], v14 offset:39936
    v_mfma_f32_16x16x32_bf16 v[56:59], v[116:119], v[156:159], v[56:59]
    ds_read_b128 v[140:143], v14 offset:41984
    v_mfma_f32_16x16x32_bf16 v[60:63], v[116:119], v[160:163], v[60:63]
    ds_read_b64_tr_b16 v[112:113], v13 offset:128
    v_mfma_f32_16x16x32_bf16 v[96:99], v[116:119], v[28:31], v[96:99]
    ds_read_b64_tr_b16 v[114:115], v13 offset:1792
    ds_read_b64_tr_b16 v[116:117], v13 offset:160
    ds_read_b64_tr_b16 v[118:119], v13 offset:1824
    v_add_u32 v14, s45, v12
    s_add_u32 s45, s45, 44032
    s_cmp_eq_u32 s45, 132096
    s_cselect_b32 s45, 0, s45
    s_add_u32 s48, s48, 1
    s_cmp_lt_u32 s48, 10
    s_cbranch_scc1 L_p1_F6_loop
    s_waitcnt lgkmcnt(0)
    s_branch L_epi_F
L_p1_F7:
    s_barrier
    ds_read_b128 v[128:131], v14 offset:35840
    ds_read_b128 v[132:135], v14 offset:37888
    ds_read_b128 v[136:139], v14 offset:39936
    ds_read_b128 v[140:143], v14 offset:41984
    ds_read_b64_tr_b16 v[112:113], v13 offset:320
    ds_read_b64_tr_b16 v[114:115], v13 offset:1984
    ds_read_b64_tr_b16 v[116:117], v13 offset:352
    ds_read_b64_tr_b16 v[118:119], v13 offset:2016
    v_mov_b32 v14, v12
    s_waitcnt lgkmcnt(0)
L_p1_F7_loop:
    s_waitcnt lgkmcnt(2)
    v_mfma_f32_16x16x32_bf16 v[32:35], v[112:115], v[128:131], v[32:35]
    ds_read_b128 v[148:151], v14 offset:35840
    v_mfma_f32_16x16x32_bf16 v[36:39], v[112:115], v[132:135], v[36:39]
    ds_read_b128 v[152:155], v14 offset:37888
    v_mfma_f32_16x16x32_bf16 v[40:43], v[112:115], v[136:139], v[40:43]
    ds_read_b128 v[156:159], v14 offset:39936
    v_mfma_f32_16x16x32_bf16 v[44:47], v[112:115], v[140:143], v[44:47]
    ds_read_b128 v[160:163], v14 offset:41984
    s_waitcnt lgkmcnt(4)
    v_mfma_f32_16x16x32_bf16 v[48:51], v[116:119], v[128:131], v[48:51]
    ds_read_b64_tr_b16 v[112:113], v13 offset:14144
    v_mfma_f32_16x16x32_bf16 v[52:55], v[116:119], v[132:135], v[52:55]
    ds_read_b64_tr_b16 v[114:115], v13 offset:15808
    v_mfma_f32_16x16x32_bf16 v[56:59], v[116:119], v[136:139], v[56:59]
    v_mfma_f32_16x16x32_bf16 v[60:63], v[116:119], v[140:143], v[60:63]
    v_mfma_f32_16x16x32_bf16 v[96:99], v[116:119], v[28:31], v[96:99]
    ds_read_b64_tr_b16 v[116:117], v13 offset:14176
    ds_read_b64_tr_b16 v[118:119], v13 offset:15840
    s_waitcnt lgkmcnt(2)
    v_mfma_f32_16x16x32_bf16 v[32:35], v[112:115], v[148:151], v[32:35]
    v_mfma_f32_16x16x32_bf16 v[36:39], v[112:115], v[152:155], v[36:39]
    v_mfma_f32_16x16x32_bf16 v[40:43], v[112:115], v[156:159], v[40:43]
    v_mfma_f32_16x16x32_bf16 v[44:47], v[112:115], v[160:163], v[44:47]
    v_add_u32 v14, s45, v11
    v_add_u32 v13, s45, v10
    s_cmp_gt_u32 s48, 6
    s_cbranch_scc1 L_p1_F7_nt
    s_call_b64 s[96:97], L_task
L_p1_F7_nt:
    s_waitcnt lgkmcnt(0)
    s_barrier
    v_mfma_f32_16x16x32_bf16 v[48:51], v[116:119], v[148:151], v[48:51]
    ds_read_b128 v[128:131], v14 offset:35840
    ds_read_b128 v[132:135], v14 offset:37888
    v_mfma_f32_16x16x32_bf16 v[52:55], v[116:119], v[152:155], v[52:55]
    ds_read_b128 v[136:139], v14 offset:39936
    v_mfma_f32_16x16x32_bf16 v[56:59], v[116:119], v[156:159], v[56:59]
    ds_read_b128 v[140:143], v14 offset:41984
    v_mfma_f32_16x16x32_bf16 v[60:63], v[116:119], v[160:163], v[60:63]
    ds_read_b64_tr_b16 v[112:113], v13 offset:320
    v_mfma_f32_16x16x32_bf16 v[96:99], v[116:119], v[28:31], v[96:99]
    ds_read_b64_tr_b16 v[114:115], v13 offset:1984
    ds_read_b64_tr_b16 v[116:117], v13 offset:352
    ds_read_b64_tr_b16 v[118:119], v13 offset:2016
    v_add_u32 v14, s45, v12
    s_add_u32 s45, s45, 44032
    s_cmp_eq_u32 s45, 132096
    s_cselect_b32 s45, 0, s45
    s_add_u32 s48, s48, 1
    s_cmp_lt_u32 s48, 10
    s_cbranch_scc1 L_p1_F7_loop
    s_waitcnt lgkmcnt(0)
    s_branch L_epi_F
L_epi_Q:
    ds_read_b32 v128, v18 offset:128
    ds_read_b32 v129, v18 offset:256
    ds_read_b32 v130, v18 offset:384
    ds_read_b32 v131, v18 offset:512
    ds_read_b32 v132, v17
    s_mov_b64 exec, s[52:53]
    s_nop 1
    s_cmp_le_u32 s73, 0
    s_cbranch_scc1 L_q_cs_done
    ds_write_b128 v16, v[96:99] offset:0
    s_cmp_le_u32 s73, 1
    s_cbranch_scc1 L_q_cs_done
    ds_write_b128 v16, v[100:103] offset:64
    s_cmp_le_u32 s73, 2
    s_cbranch_scc1 L_q_cs_done
    ds_write_b128 v16, v[104:107] offset:128
    s_cmp_le_u32 s73, 3
    s_cbranch_scc1 L_q_cs_done
    ds_write_b128 v16, v[108:111] offset:192
L_q_cs_done:
    s_mov_b64 exec, -1
    s_waitcnt lgkmcnt(0)
    s_barrier
    ds_read_b128 v[112:115], v15 offset:0
    ds_read_b128 v[116:119], v15 offset:64
    ds_read_b128 v[120:123], v15 offset:128
    ds_read_b128 v[124:127], v15 offset:192
    ds_read_b128 v[136:139], v16 offset:0
    ds_read_b128 v[140:143], v16 offset:64
    ds_read_b128 v[144:147], v16 offset:128
    ds_read_b128 v[148:151], v16 offset:192
    ds_read_b128 v[152:155], v5 offset:0
    ds_read_b128 v[156:159], v5 offset:16
    ds_read_b128 v[160:163], v5 offset:32
    ds_read_b32 v164, v19 offset:32
    s_waitcnt lgkmcnt(11)
    v_fmac_f32 v32, v112, v128
    v_fmac_f32 v33, v113, v128
    v_fmac_f32 v34, v114, v128
    v_fmac_f32 v35, v115, v128
    v_cvt_pk_bf16_f32 v32, v32, v33
    v_cvt_pk_bf16_f32 v33, v34, v35
    ds_write_b64 v8, v[32:33] offset:0
    v_fmac_f32 v36, v112, v129
    v_fmac_f32 v37, v113, v129
    v_fmac_f32 v38, v114, v129
    v_fmac_f32 v39, v115, v129
    v_cvt_pk_bf16_f32 v36, v36, v37
    v_cvt_pk_bf16_f32 v37, v38, v39
    ds_write_b64 v8, v[36:37] offset:2560
    v_fmac_f32 v40, v112, v130
    v_fmac_f32 v41, v113, v130
    v_fmac_f32 v42, v114, v130
    v_fmac_f32 v43, v115, v130
    v_cvt_pk_bf16_f32 v40, v40, v41
    v_cvt_pk_bf16_f32 v41, v42, v43
    ds_write_b64 v8, v[40:41] offset:128
    v_fmac_f32 v44, v112, v131
    v_fmac_f32 v45, v113, v131
    v_fmac_f32 v46, v114, v131
    v_fmac_f32 v47, v115, v131
    v_cvt_pk_bf16_f32 v44, v44, v45
    v_cvt_pk_bf16_f32 v45, v46, v47
    ds_write_b64 v8, v[44:45] offset:2688
    s_waitcnt lgkmcnt(12)
    v_fmac_f32 v48, v116, v128
    v_fmac_f32 v49, v117, v128
    v_fmac_f32 v50, v118, v128
    v_fmac_f32 v51, v119, v128
    v_cvt_pk_bf16_f32 v48, v48, v49
    v_cvt_pk_bf16_f32 v49, v50, v51
    ds_write_b64 v8, v[48:49] offset:5120
    v_fmac_f32 v52, v116, v129
    v_fmac_f32 v53, v117, v129
    v_fmac_f32 v54, v118, v129
    v_fmac_f32 v55, v119, v129
    v_cvt_pk_bf16_f32 v52, v52, v53
    v_cvt_pk_bf16_f32 v53, v54, v55
    ds_write_b64 v8, v[52:53] offset:7680
    v_fmac_f32 v56, v116, v130
    v_fmac_f32 v57, v117, v130
    v_fmac_f32 v58, v118, v130
    v_fmac_f32 v59, v119, v130
    v_cvt_pk_bf16_f32 v56, v56, v57
    v_cvt_pk_bf16_f32 v57, v58, v59
    ds_write_b64 v8, v[56:57] offset:5248
    v_fmac_f32 v60, v116, v131
    v_fmac_f32 v61, v117, v131
    v_fmac_f32 v62, v118, v131
    v_fmac_f32 v63, v119, v131
    v_cvt_pk_bf16_f32 v60, v60, v61
    v_cvt_pk_bf16_f32 v61, v62, v63
    ds_write_b64 v8, v[60:61] offset:7808
    v_fmac_f32 v64, v120, v128
    v_fmac_f32 v65, v121, v128
    v_fmac_f32 v66, v122, v128
    v_fmac_f32 v67, v123, v128
    v_cvt_pk_bf16_f32 v64, v64, v65
    v_cvt_pk_bf16_f32 v65, v66, v67
    ds_write_b64 v8, v[64:65] offset:10240
    v_fmac_f32 v68, v120, v129
    v_fmac_f32 v69, v121, v129
    v_fmac_f32 v70, v122, v129
    v_fmac_f32 v71, v123, v129
    v_cvt_pk_bf16_f32 v68, v68, v69
    v_cvt_pk_bf16_f32 v69, v70, v71
    ds_write_b64 v8, v[68:69] offset:12800
    v_fmac_f32 v72, v120, v130
    v_fmac_f32 v73, v121, v130
    v_fmac_f32 v74, v122, v130
    v_fmac_f32 v75, v123, v130
    v_cvt_pk_bf16_f32 v72, v72, v73
    v_cvt_pk_bf16_f32 v73, v74, v75
    ds_write_b64 v8, v[72:73] offset:10368
    v_fmac_f32 v76, v120, v131
    v_fmac_f32 v77, v121, v131
    v_fmac_f32 v78, v122, v131
    v_fmac_f32 v79, v123, v131
    v_cvt_pk_bf16_f32 v76, v76, v77
    v_cvt_pk_bf16_f32 v77, v78, v79
    ds_write_b64 v8, v[76:77] offset:12928
    s_cmp_eq_u32 s74, 3
    s_cbranch_scc1 L_q_skip3
    v_fmac_f32 v80, v124, v128
    v_fmac_f32 v81, v125, v128
    v_fmac_f32 v82, v126, v128
    v_fmac_f32 v83, v127, v128
    v_cvt_pk_bf16_f32 v80, v80, v81
    v_cvt_pk_bf16_f32 v81, v82, v83
    ds_write_b64 v8, v[80:81] offset:15360
    v_fmac_f32 v84, v124, v129
    v_fmac_f32 v85, v125, v129
    v_fmac_f32 v86, v126, v129
    v_fmac_f32 v87, v127, v129
    v_cvt_pk_bf16_f32 v84, v84, v85
    v_cvt_pk_bf16_f32 v85, v86, v87
    ds_write_b64 v8, v[84:85] offset:17920
    v_fmac_f32 v88, v124, v130
    v_fmac_f32 v89, v125, v130
    v_fmac_f32 v90, v126, v130
    v_fmac_f32 v91, v127, v130
    v_cvt_pk_bf16_f32 v88, v88, v89
    v_cvt_pk_bf16_f32 v89, v90, v91
    ds_write_b64 v8, v[88:89] offset:15488
    v_fmac_f32 v92, v124, v131
    v_fmac_f32 v93, v125, v131
    v_fmac_f32 v94, v126, v131
    v_fmac_f32 v95, v127, v131
    v_cvt_pk_bf16_f32 v92, v92, v93
    v_cvt_pk_bf16_f32 v93, v94, v95
    ds_write_b64 v8, v[92:93] offset:18048
L_q_skip3:
    s_waitcnt lgkmcnt(12)
    s_cmp_le_u32 s73, 0
    s_cbranch_scc1 L_q_halo_done
    v_fmac_f32 v96, v136, v132
    v_fmac_f32 v97, v137, v132
    v_fmac_f32 v98, v138, v132
    v_fmac_f32 v99, v139, v132
    v_cvt_pk_bf16_f32 v96, v96, v97
    v_cvt_pk_bf16_f32 v97, v98, v99
    ds_write_b64 v9, v[96:97] offset:0
    s_cmp_le_u32 s73, 1
    s_cbranch_scc1 L_q_halo_done
    v_fmac_f32 v100, v140, v132
    v_fmac_f32 v101, v141, v132
    v_fmac_f32 v102, v142, v132
    v_fmac_f32 v103, v143, v132
    v_cvt_pk_bf16_f32 v100, v100, v101
    v_cvt_pk_bf16_f32 v101, v102, v103
    ds_write_b64 v9, v[100:101] offset:5120
    s_cmp_le_u32 s73, 2
    s_cbranch_scc1 L_q_halo_done
    v_fmac_f32 v104, v144, v132
    v_fmac_f32 v105, v145, v132
    v_fmac_f32 v106, v146, v132
    v_fmac_f32 v107, v147, v132
    v_cvt_pk_bf16_f32 v104, v104, v105
    v_cvt_pk_bf16_f32 v105, v106, v107
    ds_write_b64 v9, v[104:105] offset:10240
    s_cmp_le_u32 s73, 3
    s_cbranch_scc1 L_q_halo_done
    v_fmac_f32 v108, v148, v132
    v_fmac_f32 v109, v149, v132
    v_fmac_f32 v110, v150, v132
    v_fmac_f32 v111, v151, v132
    v_cvt_pk_bf16_f32 v108, v108, v109
    v_cvt_pk_bf16_f32 v109, v110, v111
    ds_write_b64 v9, v[108:109] offset:15360
L_q_halo_done:
    v_mul_f32 v164, 0x3ea52b5c, v164
    s_waitcnt lgkmcnt(0)
    s_barrier
    ds_read_b64 v[92:93], v3 offset:0
    ds_read_b64 v[32:33], v2 offset:0
    ds_read_b64 v[34:35], v2 offset:32
    ds_read_b64 v[36:37], v2 offset:64
    ds_read_b64 v[94:95], v3 offset:5120
    ds_read_b64 v[38:39], v2 offset:5120
    ds_read_b64 v[40:41], v2 offset:5152
    ds_read_b64 v[42:43], v2 offset:5184
    ds_read_b64 v[96:97], v3 offset:10240
    ds_read_b64 v[44:45], v2 offset:10240
    ds_read_b64 v[46:47], v2 offset:10272
    ds_read_b64 v[48:49], v2 offset:10304
    s_waitcnt lgkmcnt(8)
    v_mfma_f32_4x4x4_16b_bf16 v[112:115], v[32:33], v[92:93], 0
    v_mfma_f32_4x4x4_16b_bf16 v[116:119], v[34:35], v[92:93], 0
    v_mfma_f32_4x4x4_16b_bf16 v[120:123], v[36:37], v[92:93], 0
    ds_read_b64 v[98:99], v3 offset:15360
    ds_read_b64 v[50:51], v2 offset:15360
    ds_read_b64 v[52:53], v2 offset:15392
    ds_read_b64 v[54:55], v2 offset:15424
    s_waitcnt lgkmcnt(8)
    v_mfma_f32_4x4x4_16b_bf16 v[112:115], v[38:39], v[94:95], v[112:115]
    v_mfma_f32_4x4x4_16b_bf16 v[116:119], v[40:41], v[94:95], v[116:119]
    v_mfma_f32_4x4x4_16b_bf16 v[120:123], v[42:43], v[94:95], v[120:123]
    ds_read_b64 v[100:101], v3 offset:20480
    ds_read_b64 v[56:57], v2 offset:20480
    ds_read_b64 v[58:59], v2 offset:20512
    ds_read_b64 v[60:61], v2 offset:20544
    s_waitcnt lgkmcnt(8)
    v_mfma_f32_4x4x4_16b_bf16 v[112:115], v[44:45], v[96:97], v[112:115]
    v_mfma_f32_4x4x4_16b_bf16 v[116:119], v[46:47], v[96:97], v[116:119]
    v_mfma_f32_4x4x4_16b_bf16 v[120:123], v[48:49], v[96:97], v[120:123]
    s_waitcnt lgkmcnt(4)
    v_mfma_f32_4x4x4_16b_bf16 v[112:115], v[50:51], v[98:99], v[112:115]
    v_mfma_f32_4x4x4_16b_bf16 v[116:119], v[52:53], v[98:99], v[116:119]
    v_mfma_f32_4x4x4_16b_bf16 v[120:123], v[54:55], v[98:99], v[120:123]
    s_waitcnt lgkmcnt(0)
    v_mfma_f32_4x4x4_16b_bf16 v[112:115], v[56:57], v[100:101], v[112:115]
    v_mfma_f32_4x4x4_16b_bf16 v[116:119], v[58:59], v[100:101], v[116:119]
    v_mfma_f32_4x4x4_16b_bf16 v[120:123], v[60:61], v[100:101], v[120:123]
    ds_read_b64_tr_b16 v[62:63], v4 offset:25600
    ds_read_b64_tr_b16 v[64:65], v4 offset:30720
    ds_read_b64_tr_b16 v[66:67], v4 offset:35840
    ds_read_b64_tr_b16 v[68:69], v4 offset:40960
    ds_read_b64_tr_b16 v[70:71], v4 offset:46080
    ds_read_b64_tr_b16 v[72:73], v4 offset:25632
    ds_read_b64_tr_b16 v[74:75], v4 offset:30752
    ds_read_b64_tr_b16 v[76:77], v4 offset:35872
    ds_read_b64_tr_b16 v[78:79], v4 offset:40992
    ds_read_b64_tr_b16 v[80:81], v4 offset:46112
    ds_read_b64_tr_b16 v[82:83], v4 offset:25664
    ds_read_b64_tr_b16 v[84:85], v4 offset:30784
    ds_read_b64_tr_b16 v[86:87], v4 offset:35904
    ds_read_b64_tr_b16 v[88:89], v4 offset:41024
    ds_read_b64_tr_b16 v[90:91], v4 offset:46144
    v_fma_f32 v113, v113, v153, v20
    v_fma_f32 v114, v114, v154, v21
    v_fma_f32 v115, v115, v155, v22
    v_fma_f32 v116, v116, v156, v23
    v_fma_f32 v117, v117, v157, v24
    v_fma_f32 v118, v118, v158, v25
    v_fma_f32 v119, v119, v159, v26
    v_mul_f32 v120, v120, v160
    v_fma_f32 v121, v121, v161, v27
    v_fma_f32 v122, v122, v162, v28
    v_fma_f32 v123, v123, v163, v29
    v_max3_f32 v136, v113, v114, v115
    v_max3_f32 v137, v116, v117, v118
    v_max3_f32 v138, v119, v120, v121
    v_max3_f32 v136, v136, v122, v123
    v_max3_f32 v136, v136, v137, v138
    v_mul_f32 v136, v136, v164
    v_fma_f32 v113, v113, v164, -v136
    v_fma_f32 v114, v114, v164, -v136
    v_fma_f32 v115, v115, v164, -v136
    v_fma_f32 v116, v116, v164, -v136
    v_fma_f32 v117, v117, v164, -v136
    v_fma_f32 v118, v118, v164, -v136
    v_fma_f32 v119, v119, v164, -v136
    v_fma_f32 v120, v120, v164, -v136
    v_fma_f32 v121, v121, v164, -v136
    v_fma_f32 v122, v122, v164, -v136
    v_fma_f32 v123, v123, v164, -v136
    v_exp_f32 v113, v113
    v_exp_f32 v114, v114
    v_exp_f32 v115, v115
    v_exp_f32 v116, v116
    v_exp_f32 v117, v117
    v_exp_f32 v118, v118
    v_exp_f32 v119, v119
    v_exp_f32 v120, v120
    v_exp_f32 v121, v121
    v_exp_f32 v122, v122
    v_exp_f32 v123, v123
    v_add_f32 v136, v113, v114
    v_add_f32 v137, v115, v116
    v_add_f32 v136, v136, v117
    v_add_f32 v137, v137, v118
    v_add_f32 v136, v136, v119
    v_add_f32 v137, v137, v120
    v_add_f32 v136, v136, v121
    v_add_f32 v137, v137, v122
    v_add_f32 v136, v136, v123
    v_add_f32 v136, v136, v137
    v_rcp_f32 v136, v136
    v_mov_b32 v112, 0
    v_mul_f32 v113, v113, v153
    v_mul_f32 v114, v114, v154
    v_mul_f32 v115, v115, v155
    v_mul_f32 v116, v116, v156
    v_mul_f32 v117, v117, v157
    v_mul_f32 v118, v118, v158
    v_mul_f32 v119, v119, v159
    v_mul_f32 v120, v120, v160
    v_mul_f32 v121, v121, v161
    v_mul_f32 v122, v122, v162
    v_mul_f32 v123, v123, v163
    v_cvt_pk_bf16_f32 v104, v112, v113
    v_cvt_pk_bf16_f32 v105, v114, v115
    v_cvt_pk_bf16_f32 v106, v116, v117
    v_cvt_pk_bf16_f32 v107, v118, v119
    v_cvt_pk_bf16_f32 v108, v120, v121
    v_cvt_pk_bf16_f32 v109, v122, v123
    s_waitcnt lgkmcnt(0)
    s_nop 0
    v_mfma_f32_4x4x4_16b_bf16 v[32:35], v[62:63], v[104:105], 0
    v_mfma_f32_4x4x4_16b_bf16 v[36:39], v[64:65], v[104:105], 0
    v_mfma_f32_4x4x4_16b_bf16 v[40:43], v[66:67], v[104:105], 0
    v_mfma_f32_4x4x4_16b_bf16 v[44:47], v[68:69], v[104:105], 0
    v_mfma_f32_4x4x4_16b_bf16 v[48:51], v[70:71], v[104:105], 0
    v_mfma_f32_4x4x4_16b_bf16 v[32:35], v[72:73], v[106:107], v[32:35]
    v_mfma_f32_4x4x4_16b_bf16 v[36:39], v[74:75], v[106:107], v[36:39]
    v_mfma_f32_4x4x4_16b_bf16 v[40:43], v[76:77], v[106:107], v[40:43]
    v_mfma_f32_4x4x4_16b_bf16 v[44:47], v[78:79], v[106:107], v[44:47]
    v_mfma_f32_4x4x4_16b_bf16 v[48:51], v[80:81], v[106:107], v[48:51]
    v_mfma_f32_4x4x4_16b_bf16 v[32:35], v[82:83], v[108:109], v[32:35]
    v_mfma_f32_4x4x4_16b_bf16 v[36:39], v[84:85], v[108:109], v[36:39]
    v_mfma_f32_4x4x4_16b_bf16 v[40:43], v[86:87], v[108:109], v[40:43]
    v_mfma_f32_4x4x4_16b_bf16 v[44:47], v[88:89], v[108:109], v[44:47]
    v_mfma_f32_4x4x4_16b_bf16 v[48:51], v[90:91], v[108:109], v[48:51]
    s_nop 1
    v_mul_f32 v32, v32, v136
    v_mul_f32 v33, v33, v136
    v_mul_f32 v34, v34, v136
    v_mul_f32 v35, v35, v136
    v_cvt_pk_bf16_f32 v124, v32, v33
    v_cvt_pk_bf16_f32 v125, v34, v35
    v_mul_f32 v36, v36, v136
    v_mul_f32 v37, v37, v136
    v_mul_f32 v38, v38, v136
    v_mul_f32 v39, v39, v136
    v_cvt_pk_bf16_f32 v126, v36, v37
    v_cvt_pk_bf16_f32 v127, v38, v39
    v_mul_f32 v40, v40, v136
    v_mul_f32 v41, v41, v136
    v_mul_f32 v42, v42, v136
    v_mul_f32 v43, v43, v136
    v_cvt_pk_bf16_f32 v128, v40, v41
    v_cvt_pk_bf16_f32 v129, v42, v43
    v_mul_f32 v44, v44, v136
    v_mul_f32 v45, v45, v136
    v_mul_f32 v46, v46, v136
    v_mul_f32 v47, v47, v136
    v_cvt_pk_bf16_f32 v130, v44, v45
    v_cvt_pk_bf16_f32 v131, v46, v47
    v_mul_f32 v48, v48, v136
    v_mul_f32 v49, v49, v136
    v_mul_f32 v50, v50, v136
    v_mul_f32 v51, v51, v136
    v_cvt_pk_bf16_f32 v132, v48, v49
    v_cvt_pk_bf16_f32 v133, v50, v51
    buffer_store_dwordx4 v[124:127], v6, s[16:19], s75 offen sc1
    buffer_store_dwordx4 v[128:131], v6, s[16:19], s75 offen offset:1024 sc1
    buffer_store_dwordx2 v[132:133], v7, s[16:19], s76 offen sc1
    s_branch L_p2
L_epi_F:
    s_setprio 0
    ds_read_b64 v[160:161], v6 offset:0
    ds_read_b64 v[162:163], v6 offset:128
    ds_read_b64 v[164:165], v6 offset:256
    ds_read_b64 v[166:167], v6 offset:384
    ds_read_b128 v[128:131], v4 offset:768
    ds_read_b128 v[132:135], v4 offset:832
    ds_read_b128 v[136:139], v4 offset:896
    ds_read_b128 v[140:143], v4 offset:960
    s_mov_b64 exec, s[52:53]
    ds_write_b128 v5, v[96:99]
    s_cmp_le_u32 s73, 1
    s_cbranch_scc1 L_f_cs_done
    ds_write_b128 v5, v[100:103] offset:64
L_f_cs_done:
    s_mov_b64 exec, -1
    s_lshl_b32 s56, s43, 3
    s_lshl_b32 s57, s70, 2
    s_add_u32 s56, s56, s57
    s_mul_i32 s56, s56, 68
    s_mul_i32 s57, s42, 6
    s_add_u32 s56, s56, s57
    s_lshr_b32 s57, s71, 1
    s_add_u32 s56, s56, s57
    s_lshl_b32 s56, s56, 10
    s_add_u32 s57, s56, 69632
    s_add_u32 s58, s56, 139264
    s_add_u32 s59, s56, 208896
    s_waitcnt lgkmcnt(0)
    s_barrier
    ds_read_b128 v[112:115], v4 offset:0
    ds_read_b128 v[116:119], v4 offset:64
    ds_read_b128 v[120:123], v4 offset:128
    ds_read_b128 v[124:127], v4 offset:192
    s_waitcnt lgkmcnt(2)
    v_fmac_f32 v32, v112, v160
    v_fmac_f32 v33, v113, v160
    v_fmac_f32 v34, v114, v160
    v_fmac_f32 v35, v115, v160
    v_fma_f32 v32, v32, v161, v128
    v_fma_f32 v33, v33, v161, v129
    v_fma_f32 v34, v34, v161, v130
    v_fma_f32 v35, v35, v161, v131
    v_mul_f32 v32, v32, abs(v32)
    v_mul_f32 v33, v33, abs(v33)
    v_mul_f32 v34, v34, abs(v34)
    v_mul_f32 v35, v35, abs(v35)
    v_cvt_pk_bf16_f32 v144, v32, v33
    v_cvt_pk_bf16_f32 v145, v34, v35
    v_pk_max_i16 v144, v144, 0
    v_pk_max_i16 v145, v145, 0
    v_fmac_f32 v48, v116, v160
    v_fmac_f32 v49, v117, v160
    v_fmac_f32 v50, v118, v160
    v_fmac_f32 v51, v119, v160
    v_fma_f32 v48, v48, v161, v132
    v_fma_f32 v49, v49, v161, v133
    v_fma_f32 v50, v50, v161, v134
    v_fma_f32 v51, v51, v161, v135
    v_mul_f32 v48, v48, abs(v48)
    v_mul_f32 v49, v49, abs(v49)
    v_mul_f32 v50, v50, abs(v50)
    v_mul_f32 v51, v51, abs(v51)
    v_cvt_pk_bf16_f32 v146, v48, v49
    v_cvt_pk_bf16_f32 v147, v50, v51
    v_pk_max_i16 v146, v146, 0
    v_pk_max_i16 v147, v147, 0
    buffer_store_dwordx4 v[144:147], v2, s[16:19], s56 offen offset:0 sc1
    v_fmac_f32 v36, v112, v162
    v_fmac_f32 v37, v113, v162
    v_fmac_f32 v38, v114, v162
    v_fmac_f32 v39, v115, v162
    v_fma_f32 v36, v36, v163, v128
    v_fma_f32 v37, v37, v163, v129
    v_fma_f32 v38, v38, v163, v130
    v_fma_f32 v39, v39, v163, v131
    v_mul_f32 v36, v36, abs(v36)
    v_mul_f32 v37, v37, abs(v37)
    v_mul_f32 v38, v38, abs(v38)
    v_mul_f32 v39, v39, abs(v39)
    v_cvt_pk_bf16_f32 v148, v36, v37
    v_cvt_pk_bf16_f32 v149, v38, v39
    v_pk_max_i16 v148, v148, 0
    v_pk_max_i16 v149, v149, 0
    v_fmac_f32 v52, v116, v162
    v_fmac_f32 v53, v117, v162
    v_fmac_f32 v54, v118, v162
    v_fmac_f32 v55, v119, v162
    v_fma_f32 v52, v52, v163, v132
    v_fma_f32 v53, v53, v163, v133
    v_fma_f32 v54, v54, v163, v134
    v_fma_f32 v55, v55, v163, v135
    v_mul_f32 v52, v52, abs(v52)
    v_mul_f32 v53, v53, abs(v53)
    v_mul_f32 v54, v54, abs(v54)
    v_mul_f32 v55, v55, abs(v55)
    v_cvt_pk_bf16_f32 v150, v52, v53
    v_cvt_pk_bf16_f32 v151, v54, v55
    v_pk_max_i16 v150, v150, 0
    v_pk_max_i16 v151, v151, 0
    buffer_store_dwordx4 v[148:151], v2, s[16:19], s57 offen offset:0 sc1
    v_fmac_f32 v40, v112, v164
    v_fmac_f32 v41, v113, v164
    v_fmac_f32 v42, v114, v164
    v_fmac_f32 v43, v115, v164
    v_fma_f32 v40, v40, v165, v128
    v_fma_f32 v41, v41, v165, v129
    v_fma_f32 v42, v42, v165, v130
    v_fma_f32 v43, v43, v165, v131
    v_mul_f32 v40, v40, abs(v40)
    v_mul_f32 v41, v41, abs(v41)
    v_mul_f32 v42, v42, abs(v42)
    v_mul_f32 v43, v43, abs(v43)
    v_cvt_pk_bf16_f32 v152, v40, v41
    v_cvt_pk_bf16_f32 v153, v42, v43
    v_pk_max_i16 v152, v152, 0
    v_pk_max_i16 v153, v153, 0
    v_fmac_f32 v56, v116, v164
    v_fmac_f32 v57, v117, v164
    v_fmac_f32 v58, v118, v164
    v_fmac_f32 v59, v119, v164
    v_fma_f32 v56, v56, v165, v132
    v_fma_f32 v57, v57, v165, v133
    v_fma_f32 v58, v58, v165, v134
    v_fma_f32 v59, v59, v165, v135
    v_mul_f32 v56, v56, abs(v56)
    v_mul_f32 v57, v57, abs(v57)
    v_mul_f32 v58, v58, abs(v58)
    v_mul_f32 v59, v59, abs(v59)
    v_cvt_pk_bf16_f32 v154, v56, v57
    v_cvt_pk_bf16_f32 v155, v58, v59
    v_pk_max_i16 v154, v154, 0
    v_pk_max_i16 v155, v155, 0
    buffer_store_dwordx4 v[152:155], v2, s[16:19], s58 offen offset:0 sc1
    v_fmac_f32 v44, v112, v166
    v_fmac_f32 v45, v113, v166
    v_fmac_f32 v46, v114, v166
    v_fmac_f32 v47, v115, v166
    v_fma_f32 v44, v44, v167, v128
    v_fma_f32 v45, v45, v167, v129
    v_fma_f32 v46, v46, v167, v130
    v_fma_f32 v47, v47, v167, v131
    v_mul_f32 v44, v44, abs(v44)
    v_mul_f32 v45, v45, abs(v45)
    v_mul_f32 v46, v46, abs(v46)
    v_mul_f32 v47, v47, abs(v47)
    v_cvt_pk_bf16_f32 v156, v44, v45
    v_cvt_pk_bf16_f32 v157, v46, v47
    v_pk_max_i16 v156, v156, 0
    v_pk_max_i16 v157, v157, 0
    v_fmac_f32 v60, v116, v166
    v_fmac_f32 v61, v117, v166
    v_fmac_f32 v62, v118, v166
    v_fmac_f32 v63, v119, v166
    v_fma_f32 v60, v60, v167, v132
    v_fma_f32 v61, v61, v167, v133
    v_fma_f32 v62, v62, v167, v134
    v_fma_f32 v63, v63, v167, v135
    v_mul_f32 v60, v60, abs(v60)
    v_mul_f32 v61, v61, abs(v61)
    v_mul_f32 v62, v62, abs(v62)
    v_mul_f32 v63, v63, abs(v63)
    v_cvt_pk_bf16_f32 v158, v60, v61
    v_cvt_pk_bf16_f32 v159, v62, v63
    v_pk_max_i16 v158, v158, 0
    v_pk_max_i16 v159, v159, 0
    buffer_store_dwordx4 v[156:159], v2, s[16:19], s59 offen offset:0 sc1
    s_cmp_eq_u32 s74, 2
    s_cbranch_scc1 L_f_done
    s_waitcnt lgkmcnt(0)
    v_fmac_f32 v64, v120, v160
    v_fmac_f32 v65, v121, v160
    v_fmac_f32 v66, v122, v160
    v_fmac_f32 v67, v123, v160
    v_fma_f32 v64, v64, v161, v136
    v_fma_f32 v65, v65, v161, v137
    v_fma_f32 v66, v66, v161, v138
    v_fma_f32 v67, v67, v161, v139
    v_mul_f32 v64, v64, abs(v64)
    v_mul_f32 v65, v65, abs(v65)
    v_mul_f32 v66, v66, abs(v66)
    v_mul_f32 v67, v67, abs(v67)
    v_cvt_pk_bf16_f32 v144, v64, v65
    v_cvt_pk_bf16_f32 v145, v66, v67
    v_pk_max_i16 v144, v144, 0
    v_pk_max_i16 v145, v145, 0
    v_fmac_f32 v80, v124, v160
    v_fmac_f32 v81, v125, v160
    v_fmac_f32 v82, v126, v160
    v_fmac_f32 v83, v127, v160
    v_fma_f32 v80, v80, v161, v140
    v_fma_f32 v81, v81, v161, v141
    v_fma_f32 v82, v82, v161, v142
    v_fma_f32 v83, v83, v161, v143
    v_mul_f32 v80, v80, abs(v80)
    v_mul_f32 v81, v81, abs(v81)
    v_mul_f32 v82, v82, abs(v82)
    v_mul_f32 v83, v83, abs(v83)
    v_cvt_pk_bf16_f32 v146, v80, v81
    v_cvt_pk_bf16_f32 v147, v82, v83
    v_pk_max_i16 v146, v146, 0
    v_pk_max_i16 v147, v147, 0
    buffer_store_dwordx4 v[144:147], v2, s[16:19], s56 offen offset:1024 sc1
    v_fmac_f32 v68, v120, v162
    v_fmac_f32 v69, v121, v162
    v_fmac_f32 v70, v122, v162
    v_fmac_f32 v71, v123, v162
    v_fma_f32 v68, v68, v163, v136
    v_fma_f32 v69, v69, v163, v137
    v_fma_f32 v70, v70, v163, v138
    v_fma_f32 v71, v71, v163, v139
    v_mul_f32 v68, v68, abs(v68)
    v_mul_f32 v69, v69, abs(v69)
    v_mul_f32 v70, v70, abs(v70)
    v_mul_f32 v71, v71, abs(v71)
    v_cvt_pk_bf16_f32 v148, v68, v69
    v_cvt_pk_bf16_f32 v149, v70, v71
    v_pk_max_i16 v148, v148, 0
    v_pk_max_i16 v149, v149, 0
    v_fmac_f32 v84, v124, v162
    v_fmac_f32 v85, v125, v162
    v_fmac_f32 v86, v126, v162
    v_fmac_f32 v87, v127, v162
    v_fma_f32 v84, v84, v163, v140
    v_fma_f32 v85, v85, v163, v141
    v_fma_f32 v86, v86, v163, v142
    v_fma_f32 v87, v87, v163, v143
    v_mul_f32 v84, v84, abs(v84)
    v_mul_f32 v85, v85, abs(v85)
    v_mul_f32 v86, v86, abs(v86)
    v_mul_f32 v87, v87, abs(v87)
    v_cvt_pk_bf16_f32 v150, v84, v85
    v_cvt_pk_bf16_f32 v151, v86, v87
    v_pk_max_i16 v150, v150, 0
    v_pk_max_i16 v151, v151, 0
    buffer_store_dwordx4 v[148:151], v2, s[16:19], s57 offen offset:1024 sc1
    v_fmac_f32 v72, v120, v164
    v_fmac_f32 v73, v121, v164
    v_fmac_f32 v74, v122, v164
    v_fmac_f32 v75, v123, v164
    v_fma_f32 v72, v72, v165, v136
    v_fma_f32 v73, v73, v165, v137
    v_fma_f32 v74, v74, v165, v138
    v_fma_f32 v75, v75, v165, v139
    v_mul_f32 v72, v72, abs(v72)
    v_mul_f32 v73, v73, abs(v73)
    v_mul_f32 v74, v74, abs(v74)
    v_mul_f32 v75, v75, abs(v75)
    v_cvt_pk_bf16_f32 v152, v72, v73
    v_cvt_pk_bf16_f32 v153, v74, v75
    v_pk_max_i16 v152, v152, 0
    v_pk_max_i16 v153, v153, 0
    v_fmac_f32 v88, v124, v164
    v_fmac_f32 v89, v125, v164
    v_fmac_f32 v90, v126, v164
    v_fmac_f32 v91, v127, v164
    v_fma_f32 v88, v88, v165, v140
    v_fma_f32 v89, v89, v165, v141
    v_fma_f32 v90, v90, v165, v142
    v_fma_f32 v91, v91, v165, v143
    v_mul_f32 v88, v88, abs(v88)
    v_mul_f32 v89, v89, abs(v89)
    v_mul_f32 v90, v90, abs(v90)
    v_mul_f32 v91, v91, abs(v91)
    v_cvt_pk_bf16_f32 v154, v88, v89
    v_cvt_pk_bf16_f32 v155, v90, v91
    v_pk_max_i16 v154, v154, 0
    v_pk_max_i16 v155, v155, 0
    buffer_store_dwordx4 v[152:155], v2, s[16:19], s58 offen offset:1024 sc1
    v_fmac_f32 v76, v120, v166
    v_fmac_f32 v77, v121, v166
    v_fmac_f32 v78, v122, v166
    v_fmac_f32 v79, v123, v166
    v_fma_f32 v76, v76, v167, v136
    v_fma_f32 v77, v77, v167, v137
    v_fma_f32 v78, v78, v167, v138
    v_fma_f32 v79, v79, v167, v139
    v_mul_f32 v76, v76, abs(v76)
    v_mul_f32 v77, v77, abs(v77)
    v_mul_f32 v78, v78, abs(v78)
    v_mul_f32 v79, v79, abs(v79)
    v_cvt_pk_bf16_f32 v156, v76, v77
    v_cvt_pk_bf16_f32 v157, v78, v79
    v_pk_max_i16 v156, v156, 0
    v_pk_max_i16 v157, v157, 0
    v_fmac_f32 v92, v124, v166
    v_fmac_f32 v93, v125, v166
    v_fmac_f32 v94, v126, v166
    v_fmac_f32 v95, v127, v166
    v_fma_f32 v92, v92, v167, v140
    v_fma_f32 v93, v93, v167, v141
    v_fma_f32 v94, v94, v167, v142
    v_fma_f32 v95, v95, v167, v143
    v_mul_f32 v92, v92, abs(v92)
    v_mul_f32 v93, v93, abs(v93)
    v_mul_f32 v94, v94, abs(v94)
    v_mul_f32 v95, v95, abs(v95)
    v_cvt_pk_bf16_f32 v158, v92, v93
    v_cvt_pk_bf16_f32 v159, v94, v95
    v_pk_max_i16 v158, v158, 0
    v_pk_max_i16 v159, v159, 0
    buffer_store_dwordx4 v[156:159], v2, s[16:19], s59 offen offset:1024 sc1
L_f_done:
    s_waitcnt vmcnt(0) lgkmcnt(0)
    s_barrier
L_p2:
    v_lshlrev_b32 v11, 4, v1
    s_lshl_b32 s56, s41, 12
    s_add_u32 s56, s56, 20480
    v_add_u32 v10, s56, v11
    v_mov_b32 v32, 0
    v_mov_b32 v33, 0
    v_mov_b32 v34, 0
    v_mov_b32 v35, 0
    v_mov_b32 v36, 0
    v_mov_b32 v37, 0
    v_mov_b32 v38, 0
    v_mov_b32 v39, 0
    v_mov_b32 v40, 0
    v_mov_b32 v41, 0
    v_mov_b32 v42, 0
    v_mov_b32 v43, 0
    v_mov_b32 v44, 0
    v_mov_b32 v45, 0
    v_mov_b32 v46, 0
    v_mov_b32 v47, 0
    v_mov_b32 v48, 0
    v_mov_b32 v49, 0
    v_mov_b32 v50, 0
    v_mov_b32 v51, 0
    v_mov_b32 v52, 0
    v_mov_b32 v53, 0
    v_mov_b32 v54, 0
    v_mov_b32 v55, 0
    s_mov_b32 s44, 0
    s_mov_b32 s48, 0
    v_lshlrev_b32 v15, 7, v1
    s_lshl_b32 s75, s43, 11
    s_add_u32 s75, s75, 11730944
    s_mov_b32 s24, s66
    s_and_b32 s25, s67, 0xffff
    s_mov_b32 s26, 256
    s_mov_b32 s27, 0x00020000
    s_cmp_ge_u32 s40, 4
    s_cbranch_scc1 L_p2_1
L_p2_0:
    v_add_u32 v12, s44, v10
    v_add_u32 v13, s44, v11
    s_waitcnt lgkmcnt(0)
    s_barrier
    ds_read_b128 v[56:59], v12 offset:0
    ds_read_b128 v[60:63], v13 offset:0
    ds_read_b128 v[64:67], v13 offset:1024
    ds_read_b128 v[68:71], v13 offset:2048
    ds_read_b128 v[72:75], v12 offset:1024
    ds_read_b128 v[76:79], v13 offset:5120
    ds_read_b128 v[80:83], v13 offset:6144
    ds_read_b128 v[84:87], v13 offset:7168
    s_waitcnt lgkmcnt(0)
    ds_read_b128 v[88:91], v12 offset:2048
    ds_read_b128 v[92:95], v13 offset:10240
    v_mfma_f32_16x16x32_bf16 v[32:35], v[60:63], v[56:59], v[32:35]
    ds_read_b128 v[96:99], v13 offset:11264
    v_mfma_f32_16x16x32_bf16 v[36:39], v[64:67], v[56:59], v[36:39]
    ds_read_b128 v[100:103], v13 offset:12288
    v_mfma_f32_16x16x32_bf16 v[40:43], v[68:71], v[56:59], v[40:43]
    ds_read_b128 v[104:107], v12 offset:3072
    v_mfma_f32_16x16x32_bf16 v[32:35], v[76:79], v[72:75], v[32:35]
    ds_read_b128 v[108:111], v13 offset:15360
    v_mfma_f32_16x16x32_bf16 v[36:39], v[80:83], v[72:75], v[36:39]
    ds_read_b128 v[112:115], v13 offset:16384
    v_mfma_f32_16x16x32_bf16 v[40:43], v[84:87], v[72:75], v[40:43]
    ds_read_b128 v[116:119], v13 offset:17408
    s_add_u32 s44, s44, 36864
    s_cmp_eq_u32 s44, 147456
    s_cselect_b32 s44, 0, s44
    s_add_u32 s48, s48, 1
    s_waitcnt vmcnt(0)
L_p2_0_h:
    s_cmp_lg_u32 s40, 0
    s_cbranch_scc1 L_p2_nv
    s_cmp_lg_u32 s48, 2
    s_cbranch_scc1 L_p2_n2
    s_lshl_b32 s56, s42, 7
    s_add_u32 s56, s56, s75
    s_bitcmp1_b32 s2, 3
    s_cselect_b32 s56, 0x7f000000, s56
    v_mov_b32 v16, s30
    v_mov_b32 v17, s31
    v_mov_b32 v18, 0
    s_mov_b64 exec, 1
    buffer_store_dwordx2 v[16:17], v18, s[16:19], s56 offen sc1
    s_mov_b64 exec, -1
L_p2_n2:
    s_cmp_lg_u32 s48, 7
    s_cbranch_scc1 L_p2_n3
    s_mov_b64 exec, 0xff
    buffer_load_dwordx2 v[8:9], v15, s[16:19], s75 offen sc1
    s_mov_b64 exec, -1
L_p2_n3:
    s_cmp_lg_u32 s48, 9
    s_cbranch_scc1 L_p2_nv
    s_waitcnt vmcnt(0)
    s_mov_b64 exec, 0xff
    s_mov_b32 s63, 0
L_spin6:
    v_cmp_ne_u64 vcc, s[30:31], v[8:9]
    s_nop 1
    s_cmp_eq_u64 vcc, 0
    s_cbranch_scc1 L_spin6_ok
    s_add_u32 s63, s63, 1
    s_cmp_gt_u32 s63, 0x40000
    s_cbranch_scc1 L_spin6_ok
    s_sleep 2
    s_mov_b64 exec, 0xff
    buffer_load_dwordx2 v[8:9], v15, s[16:19], s75 offen sc1
    s_waitcnt vmcnt(0)
    s_branch L_spin6
L_spin6_ok:
    s_lshl_b32 s56, s43, 2
    s_and_b32 s57, s2, 0x1b
    s_cmp_eq_u32 s57, 0
    s_cselect_b32 s56, s56, 0x1000
    v_mov_b32 v16, 1
    v_mov_b32 v17, 0
    s_mov_b64 exec, 1
    buffer_store_dword v16, v17, s[24:27], s56 offen sc1
    s_mov_b64 exec, -1
L_p2_nv:
    v_add_u32 v12, s44, v10
    v_add_u32 v13, s44, v11
    s_waitcnt lgkmcnt(0)
    s_barrier
    ds_read_b128 v[56:59], v12 offset:0
    ds_read_b128 v[60:63], v13 offset:0
    v_mfma_f32_16x16x32_bf16 v[32:35], v[92:95], v[88:91], v[32:35]
    ds_read_b128 v[64:67], v13 offset:1024
    v_mfma_f32_16x16x32_bf16 v[36:39], v[96:99], v[88:91], v[36:39]
    ds_read_b128 v[68:71], v13 offset:2048
    v_mfma_f32_16x16x32_bf16 v[40:43], v[100:103], v[88:91], v[40:43]
    ds_read_b128 v[72:75], v12 offset:1024
    v_mfma_f32_16x16x32_bf16 v[32:35], v[108:111], v[104:107], v[32:35]
    ds_read_b128 v[76:79], v13 offset:5120
    v_mfma_f32_16x16x32_bf16 v[36:39], v[112:115], v[104:107], v[36:39]
    ds_read_b128 v[80:83], v13 offset:6144
    v_mfma_f32_16x16x32_bf16 v[40:43], v[116:119], v[104:107], v[40:43]
    ds_read_b128 v[84:87], v13 offset:7168
    s_waitcnt lgkmcnt(0)
    ds_read_b128 v[88:91], v12 offset:2048
    ds_read_b128 v[92:95], v13 offset:10240
    v_mfma_f32_16x16x32_bf16 v[32:35], v[60:63], v[56:59], v[32:35]
    ds_read_b128 v[96:99], v13 offset:11264
    v_mfma_f32_16x16x32_bf16 v[36:39], v[64:67], v[56:59], v[36:39]
    ds_read_b128 v[100:103], v13 offset:12288
    v_mfma_f32_16x16x32_bf16 v[40:43], v[68:71], v[56:59], v[40:43]
    ds_read_b128 v[104:107], v12 offset:3072
    v_mfma_f32_16x16x32_bf16 v[32:35], v[76:79], v[72:75], v[32:35]
    ds_read_b128 v[108:111], v13 offset:15360
    v_mfma_f32_16x16x32_bf16 v[36:39], v[80:83], v[72:75], v[36:39]
    ds_read_b128 v[112:115], v13 offset:16384
    v_mfma_f32_16x16x32_bf16 v[40:43], v[84:87], v[72:75], v[40:43]
    ds_read_b128 v[116:119], v13 offset:17408
    s_add_u32 s44, s44, 36864
    s_cmp_eq_u32 s44, 147456
    s_cselect_b32 s44, 0, s44
    s_add_u32 s48, s48, 1
    s_cmp_lt_u32 s48, 12
    s_cbranch_scc1 L_p2_0_h
    v_add_u32 v12, s44, v10
    v_add_u32 v13, s44, v11
    s_waitcnt lgkmcnt(0)
    s_barrier
    ds_read_b128 v[56:59], v12 offset:0
    ds_read_b128 v[60:63], v13 offset:0
    v_mfma_f32_16x16x32_bf16 v[32:35], v[92:95], v[88:91], v[32:35]
    ds_read_b128 v[64:67], v13 offset:1024
    v_mfma_f32_16x16x32_bf16 v[36:39], v[96:99], v[88:91], v[36:39]
    ds_read_b128 v[68:71], v13 offset:2048
    v_mfma_f32_16x16x32_bf16 v[40:43], v[100:103], v[88:91], v[40:43]
    ds_read_b128 v[72:75], v12 offset:1024
    v_mfma_f32_16x16x32_bf16 v[32:35], v[108:111], v[104:107], v[32:35]
    ds_read_b128 v[76:79], v13 offset:5120
    v_mfma_f32_16x16x32_bf16 v[36:39], v[112:115], v[104:107], v[36:39]
    ds_read_b128 v[80:83], v13 offset:6144
    v_mfma_f32_16x16x32_bf16 v[40:43], v[116:119], v[104:107], v[40:43]
    ds_read_b128 v[84:87], v13 offset:7168
    v_lshrrev_b32 v16, 4, v1
    v_and_b32 v17, 15, v1
    v_mul_u32_u24 v18, 80, v16
    v_add_u32 v18, 157696, v18
    v_mul_u32_u24 v19, 160, v17
    v_mul_u32_u24 v20, 40, v16
    s_mul_i32 s56, s41, 2560
    s_add_u32 s56, s56, 147456
    v_add3_u32 v19, v19, v20, s56
    v_mul_u32_u24 v21, 2560, v17
    v_add_u32 v21, v21, v20
    ds_read_b128 v[128:131], v18 offset:0
    ds_read_b128 v[132:135], v18 offset:16
    ds_read_b128 v[136:139], v18 offset:32
    ds_read_b64 v[160:161], v19 offset:0
    ds_read_b64 v[162:163], v19 offset:8
    ds_read_b64 v[164:165], v19 offset:16
    s_waitcnt lgkmcnt(0)
    ds_read_b128 v[88:91], v12 offset:2048
    ds_read_b128 v[92:95], v13 offset:10240
    v_mfma_f32_16x16x32_bf16 v[44:47], v[60:63], v[56:59], v[44:47]
    ds_read_b128 v[96:99], v13 offset:11264
    v_mfma_f32_16x16x32_bf16 v[48:51], v[64:67], v[56:59], v[48:51]
    ds_read_b128 v[100:103], v13 offset:12288
    v_mfma_f32_16x16x32_bf16 v[52:55], v[68:71], v[56:59], v[52:55]
    ds_read_b128 v[104:107], v12 offset:3072
    v_mfma_f32_16x16x32_bf16 v[44:47], v[76:79], v[72:75], v[44:47]
    ds_read_b128 v[108:111], v13 offset:15360
    v_mfma_f32_16x16x32_bf16 v[48:51], v[80:83], v[72:75], v[48:51]
    ds_read_b128 v[112:115], v13 offset:16384
    v_mfma_f32_16x16x32_bf16 v[52:55], v[84:87], v[72:75], v[52:55]
    ds_read_b128 v[116:119], v13 offset:17408
    s_add_u32 s44, s44, 36864
    s_cmp_eq_u32 s44, 147456
    s_cselect_b32 s44, 0, s44
    s_add_u32 s48, s48, 1
    s_mov_b32 s57, 0xbfb8aa3b
    v_add_f32 v32, v32, v128
    v_add_f32 v33, v33, v129
    v_add_f32 v34, v34, v130
    v_add_f32 v35, v35, v131
    v_add_f32 v36, v36, v132
    v_add_f32 v37, v37, v133
    v_add_f32 v38, v38, v134
    v_add_f32 v39, v39, v135
    v_add_f32 v40, v40, v136
    v_add_f32 v41, v41, v137
    v_add_f32 v42, v42, v138
    v_add_f32 v43, v43, v139
    v_mul_f32 v140, s57, v32
    v_mul_f32 v141, s57, v33
    v_mul_f32 v142, s57, v34
    v_mul_f32 v143, s57, v35
    v_mul_f32 v144, s57, v36
    v_mul_f32 v145, s57, v37
    v_mul_f32 v146, s57, v38
    v_mul_f32 v147, s57, v39
    v_mul_f32 v148, s57, v40
    v_mul_f32 v149, s57, v41
    v_mul_f32 v150, s57, v42
    v_mul_f32 v151, s57, v43
    v_exp_f32 v140, v140
    v_exp_f32 v141, v141
    v_exp_f32 v142, v142
    v_exp_f32 v143, v143
    v_exp_f32 v144, v144
    v_exp_f32 v145, v145
    v_exp_f32 v146, v146
    v_exp_f32 v147, v147
    v_exp_f32 v148, v148
    v_exp_f32 v149, v149
    v_exp_f32 v150, v150
    v_exp_f32 v151, v151
    v_lshlrev_b32 v128, 16, v160
    v_and_b32 v129, 0xffff0000, v160
    v_lshlrev_b32 v130, 16, v161
    v_and_b32 v131, 0xffff0000, v161
    v_lshlrev_b32 v132, 16, v162
    v_and_b32 v133, 0xffff0000, v162
    v_lshlrev_b32 v134, 16, v163
    v_and_b32 v135, 0xffff0000, v163
    v_lshlrev_b32 v136, 16, v164
    v_and_b32 v137, 0xffff0000, v164
    v_lshlrev_b32 v138, 16, v165
    v_and_b32 v139, 0xffff0000, v165
    v_add_f32 v140, 1.0, v140
    v_add_f32 v141, 1.0, v141
    v_add_f32 v142, 1.0, v142
    v_add_f32 v143, 1.0, v143
    v_add_f32 v144, 1.0, v144
    v_add_f32 v145, 1.0, v145
    v_add_f32 v146, 1.0, v146
    v_add_f32 v147, 1.0, v147
    v_add_f32 v148, 1.0, v148
    v_add_f32 v149, 1.0, v149
    v_add_f32 v150, 1.0, v150
    v_add_f32 v151, 1.0, v151
    v_rcp_f32 v140, v140
    v_rcp_f32 v141, v141
    v_rcp_f32 v142, v142
    v_rcp_f32 v143, v143
    v_rcp_f32 v144, v144
    v_rcp_f32 v145, v145
    v_rcp_f32 v146, v146
    v_rcp_f32 v147, v147
    v_rcp_f32 v148, v148
    v_rcp_f32 v149, v149
    v_rcp_f32 v150, v150
    v_rcp_f32 v151, v151
    s_bfe_u32 s56, s2, 0x10001
    s_lshl_b32 s57, s43, 1
    s_add_u32 s56, s56, s57
    s_lshl_b32 s56, s56, 6
    s_lshr_b32 s57, s41, 1
    s_lshl_b32 s57, s57, 5
    s_add_u32 s56, s56, s57
    s_and_b32 s57, s41, 1
    s_add_u32 s56, s56, s57
    s_mul_i32 s56, s56, 1280
    s_and_b32 s57, s2, 1
    s_lshl_b32 s57, s57, 2
    s_bfe_u32 s58, s2, 0x20003
    s_add_u32 s57, s57, s58
    s_mul_i32 s57, s57, 160
    s_add_u32 s56, s56, s57
    s_mov_b32 s20, s64
    s_and_b32 s21, s65, 0xffff
    s_mov_b32 s22, 2621440
    s_mov_b32 s23, 0x00020000
    v_lshlrev_b32 v25, 2, v1
    s_mul_i32 s58, s41, 2560
    s_add_u32 s58, s58, 147456
    v_lshlrev_b32 v22, 4, v1
    v_mul_u32_u24 v23, 26, v1
    v_lshrrev_b32 v23, 8, v23
    v_mul_u32_u24 v23, 2400, v23
    v_add3_u32 v23, v23, v22, 0
    v_add_u32 v23, 0, v23
    v_add_u32 v22, s58, v22
    v_mul_f32 v32, v32, v140
    v_mul_f32 v33, v33, v141
    v_mul_f32 v34, v34, v142
    v_mul_f32 v35, v35, v143
    v_mul_f32 v36, v36, v144
    v_mul_f32 v37, v37, v145
    v_mul_f32 v38, v38, v146
    v_mul_f32 v39, v39, v147
    v_mul_f32 v40, v40, v148
    v_mul_f32 v41, v41, v149
    v_mul_f32 v42, v42, v150
    v_mul_f32 v43, v43, v151
L_p2_0_o:
    v_add_u32 v12, s44, v10
    v_add_u32 v13, s44, v11
    s_waitcnt lgkmcnt(0)
    s_barrier
    ds_read_b128 v[56:59], v12 offset:0
    ds_read_b128 v[60:63], v13 offset:0
    v_mfma_f32_16x16x32_bf16 v[44:47], v[92:95], v[88:91], v[44:47]
    ds_read_b128 v[64:67], v13 offset:1024
    v_mfma_f32_16x16x32_bf16 v[48:51], v[96:99], v[88:91], v[48:51]
    ds_read_b128 v[68:71], v13 offset:2048
    v_mfma_f32_16x16x32_bf16 v[52:55], v[100:103], v[88:91], v[52:55]
    ds_read_b128 v[72:75], v12 offset:1024
    v_mfma_f32_16x16x32_bf16 v[44:47], v[108:111], v[104:107], v[44:47]
    ds_read_b128 v[76:79], v13 offset:5120
    v_mfma_f32_16x16x32_bf16 v[48:51], v[112:115], v[104:107], v[48:51]
    ds_read_b128 v[80:83], v13 offset:6144
    v_mfma_f32_16x16x32_bf16 v[52:55], v[116:119], v[104:107], v[52:55]
    ds_read_b128 v[84:87], v13 offset:7168
    s_waitcnt lgkmcnt(0)
    ds_read_b128 v[88:91], v12 offset:2048
    ds_read_b128 v[92:95], v13 offset:10240
    v_mfma_f32_16x16x32_bf16 v[44:47], v[60:63], v[56:59], v[44:47]
    ds_read_b128 v[96:99], v13 offset:11264
    v_mfma_f32_16x16x32_bf16 v[48:51], v[64:67], v[56:59], v[48:51]
    ds_read_b128 v[100:103], v13 offset:12288
    v_mfma_f32_16x16x32_bf16 v[52:55], v[68:71], v[56:59], v[52:55]
    ds_read_b128 v[104:107], v12 offset:3072
    v_mfma_f32_16x16x32_bf16 v[44:47], v[76:79], v[72:75], v[44:47]
    ds_read_b128 v[108:111], v13 offset:15360
    v_mfma_f32_16x16x32_bf16 v[48:51], v[80:83], v[72:75], v[48:51]
    ds_read_b128 v[112:115], v13 offset:16384
    v_mfma_f32_16x16x32_bf16 v[52:55], v[84:87], v[72:75], v[52:55]
    ds_read_b128 v[116:119], v13 offset:17408
    s_add_u32 s44, s44, 36864
    s_cmp_eq_u32 s44, 147456
    s_cselect_b32 s44, 0, s44
    s_add_u32 s48, s48, 1
    s_cmp_lt_u32 s48, 17
    s_cbranch_scc1 L_p2_0_o
    s_waitcnt lgkmcnt(0)
    v_mfma_f32_16x16x32_bf16 v[44:47], v[92:95], v[88:91], v[44:47]
    v_mfma_f32_16x16x32_bf16 v[48:51], v[96:99], v[88:91], v[48:51]
    v_mfma_f32_16x16x32_bf16 v[52:55], v[100:103], v[88:91], v[52:55]
    v_mfma_f32_16x16x32_bf16 v[44:47], v[108:111], v[104:107], v[44:47]
    v_mfma_f32_16x16x32_bf16 v[48:51], v[112:115], v[104:107], v[48:51]
    v_mfma_f32_16x16x32_bf16 v[52:55], v[116:119], v[104:107], v[52:55]
    s_nop 7
    v_fmac_f32 v128, v32, v44
    v_fmac_f32 v129, v33, v45
    v_fmac_f32 v130, v34, v46
    v_fmac_f32 v131, v35, v47
    v_fmac_f32 v132, v36, v48
    v_fmac_f32 v133, v37, v49
    v_fmac_f32 v134, v38, v50
    v_fmac_f32 v135, v39, v51
    v_fmac_f32 v136, v40, v52
    v_fmac_f32 v137, v41, v53
    v_fmac_f32 v138, v42, v54
    v_fmac_f32 v139, v43, v55
    v_cvt_pk_bf16_f32 v140, v128, v129
    v_cvt_pk_bf16_f32 v141, v130, v131
    v_cvt_pk_bf16_f32 v142, v132, v133
    v_cvt_pk_bf16_f32 v143, v134, v135
    v_cvt_pk_bf16_f32 v144, v136, v137
    v_cvt_pk_bf16_f32 v145, v138, v139
    ds_write_b64 v19, v[140:141] offset:0
    ds_write_b64 v19, v[142:143] offset:8
    ds_write_b64 v19, v[144:145] offset:16
    s_mov_b32 s58, -1
    s_mov_b32 s59, 0xff
    s_add_u32 s57, s56, 10240
    s_waitcnt lgkmcnt(0)
    s_barrier
    s_mov_b64 exec, s[58:59]
    ds_read_b128 v[140:143], v22
    ds_read_b128 v[144:147], v22 offset:640
    s_waitcnt lgkmcnt(1)
    buffer_store_dwordx4 v[140:143], v23, s[20:23], s56 offen sc1
    s_waitcnt lgkmcnt(0)
    buffer_store_dwordx4 v[144:147], v23, s[20:23], s57 offen sc1
    s_mov_b64 exec, -1
    s_endpgm
L_p2_1:
    v_add_u32 v12, s44, v10
    v_add_u32 v13, s44, v11
    s_waitcnt lgkmcnt(0)
    s_barrier
    ds_read_b128 v[56:59], v12 offset:0
    ds_read_b128 v[60:63], v13 offset:3072
    ds_read_b128 v[64:67], v13 offset:4096
    ds_read_b128 v[68:71], v12 offset:1024
    ds_read_b128 v[72:75], v13 offset:8192
    ds_read_b128 v[76:79], v13 offset:9216
    s_waitcnt lgkmcnt(0)
    ds_read_b128 v[80:83], v12 offset:2048
    ds_read_b128 v[84:87], v13 offset:13312
    v_mfma_f32_16x16x32_bf16 v[32:35], v[60:63], v[56:59], v[32:35]
    ds_read_b128 v[88:91], v13 offset:14336
    v_mfma_f32_16x16x32_bf16 v[36:39], v[64:67], v[56:59], v[36:39]
    ds_read_b128 v[92:95], v12 offset:3072
    v_mfma_f32_16x16x32_bf16 v[32:35], v[72:75], v[68:71], v[32:35]
    ds_read_b128 v[96:99], v13 offset:18432
    v_mfma_f32_16x16x32_bf16 v[36:39], v[76:79], v[68:71], v[36:39]
    ds_read_b128 v[100:103], v13 offset:19456
    s_add_u32 s44, s44, 36864
    s_cmp_eq_u32 s44, 147456
    s_cselect_b32 s44, 0, s44
    s_add_u32 s48, s48, 1
    s_waitcnt vmcnt(0)
L_p2_1_h:
    v_add_u32 v12, s44, v10
    v_add_u32 v13, s44, v11
    s_waitcnt lgkmcnt(0)
    s_barrier
    ds_read_b128 v[56:59], v12 offset:0
    ds_read_b128 v[60:63], v13 offset:3072
    v_mfma_f32_16x16x32_bf16 v[32:35], v[84:87], v[80:83], v[32:35]
    ds_read_b128 v[64:67], v13 offset:4096
    v_mfma_f32_16x16x32_bf16 v[36:39], v[88:91], v[80:83], v[36:39]
    ds_read_b128 v[68:71], v12 offset:1024
    v_mfma_f32_16x16x32_bf16 v[32:35], v[96:99], v[92:95], v[32:35]
    ds_read_b128 v[72:75], v13 offset:8192
    v_mfma_f32_16x16x32_bf16 v[36:39], v[100:103], v[92:95], v[36:39]
    ds_read_b128 v[76:79], v13 offset:9216
    s_waitcnt lgkmcnt(0)
    ds_read_b128 v[80:83], v12 offset:2048
    ds_read_b128 v[84:87], v13 offset:13312
    v_mfma_f32_16x16x32_bf16 v[32:35], v[60:63], v[56:59], v[32:35]
    ds_read_b128 v[88:91], v13 offset:14336
    v_mfma_f32_16x16x32_bf16 v[36:39], v[64:67], v[56:59], v[36:39]
    ds_read_b128 v[92:95], v12 offset:3072
    v_mfma_f32_16x16x32_bf16 v[32:35], v[72:75], v[68:71], v[32:35]
    ds_read_b128 v[96:99], v13 offset:18432
    v_mfma_f32_16x16x32_bf16 v[36:39], v[76:79], v[68:71], v[36:39]
    ds_read_b128 v[100:103], v13 offset:19456
    s_add_u32 s44, s44, 36864
    s_cmp_eq_u32 s44, 147456
    s_cselect_b32 s44, 0, s44
    s_add_u32 s48, s48, 1
    s_cmp_lt_u32 s48, 12
    s_cbranch_scc1 L_p2_1_h
    v_add_u32 v12, s44, v10
    v_add_u32 v13, s44, v11
    s_waitcnt lgkmcnt(0)
    s_barrier
    ds_read_b128 v[56:59], v12 offset:0
    ds_read_b128 v[60:63], v13 offset:3072
    v_mfma_f32_16x16x32_bf16 v[32:35], v[84:87], v[80:83], v[32:35]
    ds_read_b128 v[64:67], v13 offset:4096
    v_mfma_f32_16x16x32_bf16 v[36:39], v[88:91], v[80:83], v[36:39]
    ds_read_b128 v[68:71], v12 offset:1024
    v_mfma_f32_16x16x32_bf16 v[32:35], v[96:99], v[92:95], v[32:35]
    ds_read_b128 v[72:75], v13 offset:8192
    v_mfma_f32_16x16x32_bf16 v[36:39], v[100:103], v[92:95], v[36:39]
    ds_read_b128 v[76:79], v13 offset:9216
    v_lshrrev_b32 v16, 4, v1
    v_and_b32 v17, 15, v1
    v_mul_u32_u24 v18, 80, v16
    v_add_u32 v18, 157744, v18
    v_mul_u32_u24 v19, 160, v17
    v_mul_u32_u24 v20, 40, v16
    s_mul_i32 s56, s41, 2560
    s_add_u32 s56, s56, 147480
    v_add3_u32 v19, v19, v20, s56
    v_mul_u32_u24 v21, 2560, v17
    v_add_u32 v21, v21, v20
    ds_read_b128 v[128:131], v18 offset:0
    ds_read_b128 v[132:135], v18 offset:16
    ds_read_b64 v[160:161], v19 offset:0
    ds_read_b64 v[162:163], v19 offset:8
    s_waitcnt lgkmcnt(0)
    ds_read_b128 v[80:83], v12 offset:2048
    ds_read_b128 v[84:87], v13 offset:13312
    v_mfma_f32_16x16x32_bf16 v[44:47], v[60:63], v[56:59], v[44:47]
    ds_read_b128 v[88:91], v13 offset:14336
    v_mfma_f32_16x16x32_bf16 v[48:51], v[64:67], v[56:59], v[48:51]
    ds_read_b128 v[92:95], v12 offset:3072
    v_mfma_f32_16x16x32_bf16 v[44:47], v[72:75], v[68:71], v[44:47]
    ds_read_b128 v[96:99], v13 offset:18432
    v_mfma_f32_16x16x32_bf16 v[48:51], v[76:79], v[68:71], v[48:51]
    ds_read_b128 v[100:103], v13 offset:19456
    s_add_u32 s44, s44, 36864
    s_cmp_eq_u32 s44, 147456
    s_cselect_b32 s44, 0, s44
    s_add_u32 s48, s48, 1
    s_mov_b32 s57, 0xbfb8aa3b
    v_add_f32 v32, v32, v128
    v_add_f32 v33, v33, v129
    v_add_f32 v34, v34, v130
    v_add_f32 v35, v35, v131
    v_add_f32 v36, v36, v132
    v_add_f32 v37, v37, v133
    v_add_f32 v38, v38, v134
    v_add_f32 v39, v39, v135
    v_mul_f32 v140, s57, v32
    v_mul_f32 v141, s57, v33
    v_mul_f32 v142, s57, v34
    v_mul_f32 v143, s57, v35
    v_mul_f32 v144, s57, v36
    v_mul_f32 v145, s57, v37
    v_mul_f32 v146, s57, v38
    v_mul_f32 v147, s57, v39
    v_exp_f32 v140, v140
    v_exp_f32 v141, v141
    v_exp_f32 v142, v142
    v_exp_f32 v143, v143
    v_exp_f32 v144, v144
    v_exp_f32 v145, v145
    v_exp_f32 v146, v146
    v_exp_f32 v147, v147
    v_lshlrev_b32 v128, 16, v160
    v_and_b32 v129, 0xffff0000, v160
    v_lshlrev_b32 v130, 16, v161
    v_and_b32 v131, 0xffff0000, v161
    v_lshlrev_b32 v132, 16, v162
    v_and_b32 v133, 0xffff0000, v162
    v_lshlrev_b32 v134, 16, v163
    v_and_b32 v135, 0xffff0000, v163
    v_add_f32 v140, 1.0, v140
    v_add_f32 v141, 1.0, v141
    v_add_f32 v142, 1.0, v142
    v_add_f32 v143, 1.0, v143
    v_add_f32 v144, 1.0, v144
    v_add_f32 v145, 1.0, v145
    v_add_f32 v146, 1.0, v146
    v_add_f32 v147, 1.0, v147
    v_rcp_f32 v140, v140
    v_rcp_f32 v141, v141
    v_rcp_f32 v142, v142
    v_rcp_f32 v143, v143
    v_rcp_f32 v144, v144
    v_rcp_f32 v145, v145
    v_rcp_f32 v146, v146
    v_rcp_f32 v147, v147
    s_bfe_u32 s56, s2, 0x10001
    s_lshl_b32 s57, s43, 1
    s_add_u32 s56, s56, s57
    s_lshl_b32 s56, s56, 6
    s_lshr_b32 s57, s41, 1
    s_lshl_b32 s57, s57, 5
    s_add_u32 s56, s56, s57
    s_and_b32 s57, s41, 1
    s_add_u32 s56, s56, s57
    s_mul_i32 s56, s56, 1280
    s_and_b32 s57, s2, 1
    s_lshl_b32 s57, s57, 2
    s_bfe_u32 s58, s2, 0x20003
    s_add_u32 s57, s57, s58
    s_mul_i32 s57, s57, 160
    s_add_u32 s56, s56, s57
    s_mov_b32 s20, s64
    s_and_b32 s21, s65, 0xffff
    s_mov_b32 s22, 2621440
    s_mov_b32 s23, 0x00020000
    v_lshlrev_b32 v25, 2, v1
    s_mul_i32 s58, s41, 2560
    s_add_u32 s58, s58, 148736
    v_lshlrev_b32 v22, 4, v1
    v_mul_u32_u24 v23, 26, v1
    v_lshrrev_b32 v23, 8, v23
    v_mul_u32_u24 v23, 2400, v23
    v_add3_u32 v23, v23, v22, 0
    v_add_u32 v23, 20480, v23
    v_add_u32 v22, s58, v22
    v_mul_f32 v32, v32, v140
    v_mul_f32 v33, v33, v141
    v_mul_f32 v34, v34, v142
    v_mul_f32 v35, v35, v143
    v_mul_f32 v36, v36, v144
    v_mul_f32 v37, v37, v145
    v_mul_f32 v38, v38, v146
    v_mul_f32 v39, v39, v147
L_p2_1_o:
    s_or_b32 s58, s41, s2
    s_cmp_lg_u32 s58, 0
    s_cbranch_scc1 L_nonce_skip
    s_mov_b64 exec, 0xffff
    s_cmp_lg_u32 s48, 13
    s_cbranch_scc1 L_nonce_b
    buffer_load_dword v24, v25, s[24:27], 0 offen sc1
L_nonce_b:
    s_cmp_lg_u32 s48, 15
    s_cbranch_scc1 L_nonce_c
    s_mov_b32 s62, 1
    s_waitcnt vmcnt(0)
    s_mov_b32 s63, 0
L_spin7:
    v_cmp_ne_u32 vcc, s62, v24
    s_nop 1
    s_cmp_eq_u64 vcc, 0
    s_cbranch_scc1 L_spin7_ok
    s_add_u32 s63, s63, 1
    s_cmp_gt_u32 s63, 0x40000
    s_cbranch_scc1 L_spin7_ok
    s_sleep 2
    buffer_load_dword v24, v25, s[24:27], 0 offen sc1
    s_waitcnt vmcnt(0)
    s_branch L_spin7
L_spin7_ok:
    v_mov_b32 v26, s30
    v_mov_b32 v27, s31
    s_mov_b32 s58, 11796480
    s_mov_b64 exec, 1
    buffer_store_dwordx2 v[26:27], v25, s[16:19], s58 offen sc1
L_nonce_c:
    s_mov_b64 exec, -1
L_nonce_skip:
    v_add_u32 v12, s44, v10
    v_add_u32 v13, s44, v11
    s_waitcnt lgkmcnt(0)
    s_barrier
    ds_read_b128 v[56:59], v12 offset:0
    ds_read_b128 v[60:63], v13 offset:3072
    v_mfma_f32_16x16x32_bf16 v[44:47], v[84:87], v[80:83], v[44:47]
    ds_read_b128 v[64:67], v13 offset:4096
    v_mfma_f32_16x16x32_bf16 v[48:51], v[88:91], v[80:83], v[48:51]
    ds_read_b128 v[68:71], v12 offset:1024
    v_mfma_f32_16x16x32_bf16 v[44:47], v[96:99], v[92:95], v[44:47]
    ds_read_b128 v[72:75], v13 offset:8192
    v_mfma_f32_16x16x32_bf16 v[48:51], v[100:103], v[92:95], v[48:51]
    ds_read_b128 v[76:79], v13 offset:9216
    s_waitcnt lgkmcnt(0)
    ds_read_b128 v[80:83], v12 offset:2048
    ds_read_b128 v[84:87], v13 offset:13312
    v_mfma_f32_16x16x32_bf16 v[44:47], v[60:63], v[56:59], v[44:47]
    ds_read_b128 v[88:91], v13 offset:14336
    v_mfma_f32_16x16x32_bf16 v[48:51], v[64:67], v[56:59], v[48:51]
    ds_read_b128 v[92:95], v12 offset:3072
    v_mfma_f32_16x16x32_bf16 v[44:47], v[72:75], v[68:71], v[44:47]
    ds_read_b128 v[96:99], v13 offset:18432
    v_mfma_f32_16x16x32_bf16 v[48:51], v[76:79], v[68:71], v[48:51]
    ds_read_b128 v[100:103], v13 offset:19456
    s_add_u32 s44, s44, 36864
    s_cmp_eq_u32 s44, 147456
    s_cselect_b32 s44, 0, s44
    s_add_u32 s48, s48, 1
    s_cmp_lt_u32 s48, 17
    s_cbranch_scc1 L_p2_1_o
    s_waitcnt lgkmcnt(0)
    v_mfma_f32_16x16x32_bf16 v[44:47], v[84:87], v[80:83], v[44:47]
    v_mfma_f32_16x16x32_bf16 v[48:51], v[88:91], v[80:83], v[48:51]
    v_mfma_f32_16x16x32_bf16 v[44:47], v[96:99], v[92:95], v[44:47]
    v_mfma_f32_16x16x32_bf16 v[48:51], v[100:103], v[92:95], v[48:51]
    s_nop 7
    v_fmac_f32 v128, v32, v44
    v_fmac_f32 v129, v33, v45
    v_fmac_f32 v130, v34, v46
    v_fmac_f32 v131, v35, v47
    v_fmac_f32 v132, v36, v48
    v_fmac_f32 v133, v37, v49
    v_fmac_f32 v134, v38, v50
    v_fmac_f32 v135, v39, v51
    v_cvt_pk_bf16_f32 v140, v128, v129
    v_cvt_pk_bf16_f32 v141, v130, v131
    v_cvt_pk_bf16_f32 v142, v132, v133
    v_cvt_pk_bf16_f32 v143, v134, v135
    ds_write_b64 v19, v[140:141] offset:0
    ds_write_b64 v19, v[142:143] offset:8
    s_mov_b32 s58, -1
    s_mov_b32 s59, 0xff
    s_add_u32 s57, s56, 10240
    s_waitcnt lgkmcnt(0)
    s_barrier
    s_mov_b64 exec, s[58:59]
    ds_read_b128 v[140:143], v22
    ds_read_b128 v[144:147], v22 offset:640
    s_waitcnt lgkmcnt(1)
    buffer_store_dwordx4 v[140:143], v23, s[20:23], s56 offen sc1
    s_waitcnt lgkmcnt(0)
    buffer_store_dwordx4 v[144:147], v23, s[20:23], s57 offen sc1
    s_mov_b64 exec, -1
    s_endpgm
L_end:
    s_endpgm
.section .rodata,"a"
.p2align 6
.amdhsa_kernel recurrent_scan__sliding_local_dilated__dense_activation_squared_relu__prompt_kernel
  .amdhsa_next_free_vgpr 168
  .amdhsa_next_free_sgpr 102
  .amdhsa_accum_offset 168
  .amdhsa_group_segment_fixed_size 0
  .amdhsa_kernarg_size 88
  .amdhsa_user_sgpr_count 2
  .amdhsa_user_sgpr_kernarg_segment_ptr 1
  .amdhsa_system_sgpr_workgroup_id_x 1
.end_amdhsa_kernel
```
